```python
import torch

def _softmax(x, axis=-1):
    return torch.softmax(x, dim=axis)

def _gelu(x):
    return torch.nn.functional.gelu(x, approximate='tanh')

def _silu(x):
    return torch.nn.functional.silu(x)

def _sigmoid(x):
    return torch.sigmoid(x)

def _layernorm(x, axis=-1, eps=1e-05):
    m = x.mean(dim=axis, keepdim=True)
    v = x.var(dim=axis, keepdim=True, unbiased=False)
    return (x - m) / torch.sqrt(v + eps)

def _scatter_add(tgt, idx, src, axis=0):
    return tgt.clone().index_add_(axis, idx, src)

def _segment_sum(src, seg, n):
    out = torch.zeros((n,) + src.shape[1:], dtype=src.dtype)
    return out.index_add_(0, seg, src)

def _pad(x, pw):
    flat = tuple((v for pair in reversed(pw) for v in pair))
    return torch.nn.functional.pad(x, flat)
kernel_name = 'adaLN_cond__ssm_conv_s4__glu_gated_geglu__prompt'

def setup_inputs():

    _w = lambda a: (lambda t: t.to(torch.bfloat16) if t.is_floating_point() else t)(torch.as_tensor(a))

    def _A_setup():
        B, L, D, N = (1, 2048, 512, 128)
        A_re = -(lambda _x: torch.exp(torch.as_tensor(_x)))((lambda *s: torch.randn(*s, dtype=torch.bfloat16) * 3.2)(D, N))
        A_im = torch.pi * (lambda *s: torch.randn(*s, dtype=torch.bfloat16) * 0.1)(D, N)
        B_re = (lambda *s: torch.randn(*s, dtype=torch.bfloat16) * 0.1)(D, N)
        B_im = (lambda *s: torch.randn(*s, dtype=torch.bfloat16) * 0.1)(D, N)
        C_re = (lambda *s: torch.randn(*s, dtype=torch.bfloat16) * 0.1)(D, N)
        C_im = (lambda *s: torch.randn(*s, dtype=torch.bfloat16) * 0.1)(D, N)
        log_dt = (lambda *s: torch.randn(*s, dtype=torch.bfloat16) * 0.1)(D) * 0.5 - 4.0
        Dskip = (lambda *s: torch.randn(*s, dtype=torch.bfloat16) * 0.1)(D)
        return {'u': _w((lambda *s: torch.randn(*s, dtype=torch.bfloat16) * 0.05)(B, L, D)), 'A_re': _w(A_re), 'A_im': _w(A_im), 'B_re': _w(B_re), 'B_im': _w(B_im), 'C_re': _w(C_re), 'C_im': _w(C_im), 'log_dt': _w(log_dt), 'Dskip': _w(Dskip)}
    _A_in = _A_setup()

    def _B_setup():
        B, S, Dm, Df = (1, 2048, 512, 1792)
        return {'x': _w((lambda *s: torch.randn(*s, dtype=torch.bfloat16) * 0.05)(B, S, Dm)), 'w_gate': _w((lambda *s: torch.randn(*s, dtype=torch.bfloat16) * 1.6)(Dm, Df) * Dm ** (-0.5)), 'w_up': _w((lambda *s: torch.randn(*s, dtype=torch.bfloat16) * 1.6)(Dm, Df) * Dm ** (-0.5)), 'w_down': _w((lambda *s: torch.randn(*s, dtype=torch.bfloat16) * 1.6)(Df, Dm) * Df ** (-0.5))}
    _B_in = _B_setup()
    return {'A_u': _A_in['u'], 'A_A_re': _A_in['A_re'], 'A_A_im': _A_in['A_im'], 'A_B_re': _A_in['B_re'], 'A_B_im': _A_in['B_im'], 'A_C_re': _A_in['C_re'], 'A_C_im': _A_in['C_im'], 'A_log_dt': _A_in['log_dt'], 'A_Dskip': _A_in['Dskip'], 'B_x': _B_in['x'], 'B_w_gate': _B_in['w_gate'], 'B_w_up': _B_in['w_up'], 'B_w_down': _B_in['w_down'], 'c': _w((lambda *s: torch.randn(*s, dtype=torch.bfloat16) * 0.1)(1, 512) * 8.0), 'w_mod': _w((lambda *s: torch.randn(*s, dtype=torch.bfloat16) * 0.1)(512, 6 * 512) * 512 ** (-0.5) * 8.0)}

def reference(A_u, A_A_re, A_A_im, A_B_re, A_B_im, A_C_re, A_C_im, A_log_dt, A_Dskip, B_x, B_w_gate, B_w_up, B_w_down, c, w_mod):

    def _A_ref(u, A_re, A_im, B_re, B_im, C_re, C_im, log_dt, Dskip):
        Bsz, L, D = u.shape
        dt = torch.exp(log_dt)[:, None]
        A = A_re + 1j * A_im
        Bc = B_re + 1j * B_im
        Cc = C_re + 1j * C_im
        logdA = dt * A
        dB = dt * Bc
        l = (lambda x, dt: x.to(dt))(torch.arange(L), A_re.dtype)
        P = torch.exp(logdA[:, :, None] * l[None, None, :])
        K = torch.einsum('dn,dnl,dn->dl', Cc, P, dB).real
        L2 = 2 * L
        Kp = _pad(K, ((0, 0), (0, L)))
        up = (lambda x, *d: x.permute(*d))(u, 0, 2, 1)
        up = _pad(up, ((0, 0), (0, 0), (0, L)))
        Kf = (lambda x, axes=(-2, -1): torch.fft.rfft2(x.float(), dim=axes))(Kp[:, None, :], axes=(-2, -1))
        Uf = (lambda x, axes=(-2, -1): torch.fft.rfft2(x.float(), dim=axes))(up[:, :, None, :], axes=(-2, -1))
        Yf = Uf * Kf[None, :, :, :]
        y = (lambda x, s, axes=(-2, -1): torch.fft.irfft2(x, s=s, dim=axes).to(torch.bfloat16))(Yf, (1, L2), axes=(-2, -1))[:, :, 0, :L]
        y = (lambda x, *d: x.permute(*d))(y, 0, 2, 1) + u * Dskip[None, None, :]
        return y

    def _B_ref(x, w_gate, w_up, w_down):
        g = torch.einsum('bsd,df->bsf', x, w_gate)
        u = torch.einsum('bsd,df->bsf', x, w_up)
        h = _gelu(g) * u
        return torch.einsum('bsf,fd->bsd', h, w_down)
    x = A_u
    mod = (_silu(c) @ w_mod).reshape(c.shape[0], 6, 1, -1)
    sa, ca, ga, sb, cb, gb = (mod[:, 0].clone(), mod[:, 1].clone(), mod[:, 2].clone(), mod[:, 3].clone(), mod[:, 4].clone(), mod[:, 5].clone())
    h = _layernorm(x, axis=-1) * (1 + ca) + sa
    x = x + ga * _A_ref(h, A_A_re, A_A_im, A_B_re, A_B_im, A_C_re, A_C_im, A_log_dt, A_Dskip)
    h = _layernorm(x, axis=-1) * (1 + cb) + sb
    x = x + gb * _B_ref(h, B_w_gate, B_w_up, B_w_down)
    return x
```

```asm
; @launch kernel=prep_kernel grid=(256,1,1) block=(512,1,1) lds=122784
; @launch kernel=gemm1_kernel grid=(256,1,1) block=(512,1,1) lds=145408
.amdgcn_target "amdgcn-amd-amdhsa--gfx950"
.text
.globl prep_kernel
.p2align 8
.type prep_kernel,@function
prep_kernel:
  s_cmp_ge_u32 s2, 256
  s_cbranch_scc1 K1_END
  s_load_dwordx2 s[4:5], s[0:1], 136
  v_xor_b32 v0, 256, v0
  v_lshrrev_b32 v87, 6, v0
  v_and_b32 v1, 63, v0
  v_readfirstlane_b32 s33, v87
  s_nop 1
  s_cmp_ge_u32 s33, 4
  s_cbranch_scc1 K1_B
  s_load_dwordx2 s[50:51], s[0:1], 128
  s_load_dwordx4 s[8:11], s[0:1], 8
  s_load_dwordx4 s[12:15], s[0:1], 24
  s_load_dwordx4 s[16:19], s[0:1], 40
  s_load_dwordx2 s[20:21], s[0:1], 56
  s_getpc_b64 s[30:31]
  s_add_u32 s30, s30, K0_TAB@rel32@lo+4
  s_addc_u32 s31, s31, K0_TAB@rel32@hi+12
  s_and_b32 s6, s2, 7
  s_lshl_b32 s6, s6, 5
  s_lshr_b32 s7, s2, 3
  s_add_u32 s6, s6, s7
  s_lshl_b32 s6, s6, 1
  s_lshl_b32 s7, s6, 8
  v_and_b32 v160, 127, v0
  v_lshlrev_b32 v161, 4, v160
  v_lshl_add_u32 v2, v0, 1, s7
  v_lshrrev_b32 v3, 7, v0
  v_add_lshl_u32 v11, v3, s6, 1
  s_waitcnt lgkmcnt(0)
  global_load_ushort v10, v11, s[20:21]
  global_load_ushort v4, v2, s[8:9]
  global_load_ushort v5, v2, s[10:11]
  global_load_ushort v6, v2, s[12:13]
  global_load_ushort v7, v2, s[14:15]
  global_load_ushort v8, v2, s[16:17]
  global_load_ushort v9, v2, s[18:19]
  s_barrier
  s_add_u32 s34, s30, 4096
  s_addc_u32 s35, s31, 0
  s_mul_i32 s36, s33, 8768
  s_add_u32 s36, s36, 40192
  v_lshl_add_u32 v164, v1, 2, s36
  v_add_u32 v165, 1088, v164
  v_add_u32 v166, 2176, v164
  v_add_u32 v167, 3264, v164
  v_and_b32 v85, 15, v1
  v_lshrrev_b32 v86, 4, v1
  v_mul_u32_u24 v88, 272, v85
  v_lshl_add_u32 v88, v86, 4, v88
  v_add_u32 v75, s36, v88
  v_mul_u32_u24 v85, 68, v85
  v_add_u32 v85, s36, v85
  v_lshl_add_u32 v120, v86, 4, v85
  v_mul_u32_u24 v87, 1088, v86
  v_lshlrev_b32 v88, 3, v86
  v_add_u32 v88, 1088, v88
  v_max_u32 v87, v87, v88
  v_add_u32 v121, v87, v85
  v_lshrrev_b32 v87, 1, v86
  v_mul_u32_u24 v87, 4352, v87
  v_and_b32 v88, 1, v86
  v_lshl_add_u32 v87, v88, 5, v87
  v_add_u32 v122, v87, v85
  v_mul_u32_u24 v2, 8448, v3
  v_add_u32 v2, v161, v2
  s_waitcnt vmcnt(6)
  v_lshlrev_b32 v10, 16, v10
  v_mul_f32 v10, 0x3fb8aa3b, v10
  v_exp_f32 v10, v10
  s_waitcnt vmcnt(0)
  global_load_dwordx4 v[124:127], v161, s[30:31] offset:0
  global_load_dwordx4 v[128:131], v161, s[30:31] offset:2048
  global_load_dwordx4 v[132:135], v161, s[34:35] offset:0
  global_load_dwordx4 v[136:139], v161, s[34:35] offset:2048
  v_mov_b32 v80, 105728
  v_mov_b32 v81, 1
  ds_write_b32 v80, v81 offset:28
  s_setprio 3
  v_lshlrev_b32 v4, 16, v4
  v_lshlrev_b32 v5, 16, v5
  v_lshlrev_b32 v6, 16, v6
  v_lshlrev_b32 v7, 16, v7
  v_lshlrev_b32 v8, 16, v8
  v_lshlrev_b32 v9, 16, v9
  v_cvt_pk_bf16_f32 v10, v10, v10
  v_lshlrev_b32 v10, 16, v10
  v_pk_mul_f32 v[12:13], v[4:5], v[10:11] op_sel:[0,0] op_sel_hi:[1,0]
  v_pk_mul_f32 v[6:7], v[6:7], v[10:11] op_sel:[0,0] op_sel_hi:[1,0]
  v_mul_f32 v12, 0x3fb8aa3b, v12
  v_mul_f32 v13, 0x3e22f983, v13
  v_mov_b32 v4, v7
  v_pk_mul_f32 v[14:15], v[8:9], v[6:7] op_sel:[0,0] op_sel_hi:[1,0]
  v_pk_fma_f32 v[14:15], v[8:9], v[4:5], v[14:15] op_sel:[1,0,0] op_sel_hi:[0,0,1] neg_lo:[1,0,0]
  v_max_f32 v72, abs(v14), abs(v15)
  v_exp_f32 v6, v12
  v_fract_f32 v7, v13
  v_max_f32_dpp v72, v72, v72 row_ror:8 row_mask:0xf bank_mask:0xf
  v_cos_f32 v16, v7
  v_sin_f32 v17, v7
  v_max_f32_dpp v72, v72, v72 row_ror:4 row_mask:0xf bank_mask:0xf
  v_mul_f32 v4, 0x41800000, v12
  v_mul_f32 v5, 0x41800000, v13
  v_max_f32_dpp v72, v72, v72 row_ror:2 row_mask:0xf bank_mask:0xf
  v_exp_f32 v4, v4
  v_fract_f32 v5, v5
  v_max_f32_dpp v72, v72, v72 row_ror:1 row_mask:0xf bank_mask:0xf
  v_cos_f32 v18, v5
  v_sin_f32 v19, v5
  v_max_f32_dpp v72, v72, v72 row_bcast:15 row_mask:0xa bank_mask:0xf
  v_pk_mul_f32 v[16:17], v[16:17], v[6:7] op_sel:[0,0] op_sel_hi:[1,0]
  v_mul_f32 v8, 0x43800000, v12
  v_max_f32_dpp v72, v72, v72 row_bcast:31 row_mask:0xc bank_mask:0xf
  v_mul_f32 v9, 0x43800000, v13
  v_exp_f32 v8, v8
  v_frexp_exp_i32_f32 v72, v72
  v_fract_f32 v9, v9
  v_cos_f32 v20, v9
  v_readlane_b32 s22, v72, 63
  v_sin_f32 v21, v9
  v_pk_mul_f32 v[18:19], v[18:19], v[4:5] op_sel:[0,0] op_sel_hi:[1,0]
  v_mov_b32 v36, 0x43800000
  v_pk_mul_f32 v[20:21], v[20:21], v[8:9] op_sel:[0,0] op_sel_hi:[1,0]
  v_mov_b32 v37, 0
  s_sub_i32 s23, 13, s22
  s_sub_i32 s24, s22, 21
  v_pk_mul_f32 v[38:39], v[16:17], v[36:37] op_sel:[0,0] op_sel_hi:[1,0]
  v_ldexp_f32 v68, v14, s23
  v_ldexp_f32 v69, v15, s23
  v_mov_b32 v6, v19
  v_mov_b32 v4, v17
  v_mov_b32 v8, v21
  v_pk_mul_f32 v[70:71], v[68:69], v[18:19] op_sel:[0,0] op_sel_hi:[1,0]
  v_pk_mul_f32 v[40:41], v[38:39], v[16:17] op_sel:[0,0] op_sel_hi:[1,0]
  v_pk_fma_f32 v[70:71], v[68:69], v[6:7], v[70:71] op_sel:[1,0,0] op_sel_hi:[0,0,1] neg_lo:[1,0,0]
  v_pk_fma_f32 v[40:41], v[38:39], v[4:5], v[40:41] op_sel:[1,0,0] op_sel_hi:[0,0,1] neg_lo:[1,0,0]
  v_cvt_pk_f16_f32 v72, v68, -v69
  v_pk_mul_f32 v[42:43], v[40:41], v[16:17] op_sel:[0,0] op_sel_hi:[1,0]
  v_pk_mul_f32 v[68:69], v[70:71], v[18:19] op_sel:[0,0] op_sel_hi:[1,0]
  v_pk_fma_f32 v[42:43], v[40:41], v[4:5], v[42:43] op_sel:[1,0,0] op_sel_hi:[0,0,1] neg_lo:[1,0,0]
  v_pk_fma_f32 v[68:69], v[70:71], v[6:7], v[68:69] op_sel:[1,0,0] op_sel_hi:[0,0,1] neg_lo:[1,0,0]
  v_pk_mul_f32 v[44:45], v[42:43], v[16:17] op_sel:[0,0] op_sel_hi:[1,0]
  v_cvt_pk_f16_f32 v73, v70, -v71
  v_pk_fma_f32 v[44:45], v[42:43], v[4:5], v[44:45] op_sel:[1,0,0] op_sel_hi:[0,0,1] neg_lo:[1,0,0]
  ds_write2_b32 v164, v72, v73 offset0:0 offset1:68
  v_pk_mul_f32 v[46:47], v[44:45], v[16:17] op_sel:[0,0] op_sel_hi:[1,0]
  v_pk_mul_f32 v[70:71], v[68:69], v[18:19] op_sel:[0,0] op_sel_hi:[1,0]
  v_pk_fma_f32 v[46:47], v[44:45], v[4:5], v[46:47] op_sel:[1,0,0] op_sel_hi:[0,0,1] neg_lo:[1,0,0]
  v_pk_fma_f32 v[70:71], v[68:69], v[6:7], v[70:71] op_sel:[1,0,0] op_sel_hi:[0,0,1] neg_lo:[1,0,0]
  v_pk_mul_f32 v[48:49], v[46:47], v[16:17] op_sel:[0,0] op_sel_hi:[1,0]
  v_cvt_pk_f16_f32 v72, v68, -v69
  v_pk_fma_f32 v[48:49], v[46:47], v[4:5], v[48:49] op_sel:[1,0,0] op_sel_hi:[0,0,1] neg_lo:[1,0,0]
  v_pk_mul_f32 v[68:69], v[70:71], v[18:19] op_sel:[0,0] op_sel_hi:[1,0]
  v_pk_mul_f32 v[50:51], v[48:49], v[16:17] op_sel:[0,0] op_sel_hi:[1,0]
  v_pk_fma_f32 v[68:69], v[70:71], v[6:7], v[68:69] op_sel:[1,0,0] op_sel_hi:[0,0,1] neg_lo:[1,0,0]
  v_pk_fma_f32 v[50:51], v[48:49], v[4:5], v[50:51] op_sel:[1,0,0] op_sel_hi:[0,0,1] neg_lo:[1,0,0]
  v_cvt_pk_f16_f32 v73, v70, -v71
  v_pk_mul_f32 v[52:53], v[50:51], v[16:17] op_sel:[0,0] op_sel_hi:[1,0]
  ds_write2_b32 v164, v72, v73 offset0:136 offset1:204
  v_pk_fma_f32 v[52:53], v[50:51], v[4:5], v[52:53] op_sel:[1,0,0] op_sel_hi:[0,0,1] neg_lo:[1,0,0]
  v_pk_mul_f32 v[70:71], v[68:69], v[18:19] op_sel:[0,0] op_sel_hi:[1,0]
  v_pk_mul_f32 v[54:55], v[52:53], v[16:17] op_sel:[0,0] op_sel_hi:[1,0]
  v_pk_fma_f32 v[70:71], v[68:69], v[6:7], v[70:71] op_sel:[1,0,0] op_sel_hi:[0,0,1] neg_lo:[1,0,0]
  v_pk_fma_f32 v[54:55], v[52:53], v[4:5], v[54:55] op_sel:[1,0,0] op_sel_hi:[0,0,1] neg_lo:[1,0,0]
  v_cvt_pk_f16_f32 v72, v68, -v69
  v_pk_mul_f32 v[56:57], v[54:55], v[16:17] op_sel:[0,0] op_sel_hi:[1,0]
  v_pk_mul_f32 v[68:69], v[70:71], v[18:19] op_sel:[0,0] op_sel_hi:[1,0]
  v_pk_fma_f32 v[56:57], v[54:55], v[4:5], v[56:57] op_sel:[1,0,0] op_sel_hi:[0,0,1] neg_lo:[1,0,0]
  v_pk_fma_f32 v[68:69], v[70:71], v[6:7], v[68:69] op_sel:[1,0,0] op_sel_hi:[0,0,1] neg_lo:[1,0,0]
  v_pk_mul_f32 v[58:59], v[56:57], v[16:17] op_sel:[0,0] op_sel_hi:[1,0]
  v_cvt_pk_f16_f32 v73, v70, -v71
  v_pk_fma_f32 v[58:59], v[56:57], v[4:5], v[58:59] op_sel:[1,0,0] op_sel_hi:[0,0,1] neg_lo:[1,0,0]
  ds_write2_b32 v165, v72, v73 offset0:0 offset1:68
  v_pk_mul_f32 v[60:61], v[58:59], v[16:17] op_sel:[0,0] op_sel_hi:[1,0]
  v_pk_mul_f32 v[70:71], v[68:69], v[18:19] op_sel:[0,0] op_sel_hi:[1,0]
  v_pk_fma_f32 v[60:61], v[58:59], v[4:5], v[60:61] op_sel:[1,0,0] op_sel_hi:[0,0,1] neg_lo:[1,0,0]
  v_pk_fma_f32 v[70:71], v[68:69], v[6:7], v[70:71] op_sel:[1,0,0] op_sel_hi:[0,0,1] neg_lo:[1,0,0]
  v_pk_mul_f32 v[62:63], v[60:61], v[16:17] op_sel:[0,0] op_sel_hi:[1,0]
  v_cvt_pk_f16_f32 v72, v68, -v69
  v_pk_fma_f32 v[62:63], v[60:61], v[4:5], v[62:63] op_sel:[1,0,0] op_sel_hi:[0,0,1] neg_lo:[1,0,0]
  v_pk_mul_f32 v[68:69], v[70:71], v[18:19] op_sel:[0,0] op_sel_hi:[1,0]
  v_pk_mul_f32 v[64:65], v[62:63], v[16:17] op_sel:[0,0] op_sel_hi:[1,0]
  v_pk_fma_f32 v[68:69], v[70:71], v[6:7], v[68:69] op_sel:[1,0,0] op_sel_hi:[0,0,1] neg_lo:[1,0,0]
  v_pk_fma_f32 v[64:65], v[62:63], v[4:5], v[64:65] op_sel:[1,0,0] op_sel_hi:[0,0,1] neg_lo:[1,0,0]
  v_cvt_pk_f16_f32 v73, v70, -v71
  v_pk_mul_f32 v[66:67], v[64:65], v[16:17] op_sel:[0,0] op_sel_hi:[1,0]
  ds_write2_b32 v165, v72, v73 offset0:136 offset1:204
  v_pk_fma_f32 v[66:67], v[64:65], v[4:5], v[66:67] op_sel:[1,0,0] op_sel_hi:[0,0,1] neg_lo:[1,0,0]
  v_pk_mul_f32 v[70:71], v[68:69], v[18:19] op_sel:[0,0] op_sel_hi:[1,0]
  v_pk_mul_f32 v[22:23], v[20:21], v[20:21] op_sel:[0,0] op_sel_hi:[1,0]
  v_pk_fma_f32 v[70:71], v[68:69], v[6:7], v[70:71] op_sel:[1,0,0] op_sel_hi:[0,0,1] neg_lo:[1,0,0]
  v_pk_fma_f32 v[22:23], v[20:21], v[8:9], v[22:23] op_sel:[1,0,0] op_sel_hi:[0,0,1] neg_lo:[1,0,0]
  v_cvt_pk_f16_f32 v72, v68, -v69
  v_pk_mul_f32 v[24:25], v[22:23], v[20:21] op_sel:[0,0] op_sel_hi:[1,0]
  v_pk_mul_f32 v[68:69], v[70:71], v[18:19] op_sel:[0,0] op_sel_hi:[1,0]
  v_pk_fma_f32 v[24:25], v[22:23], v[8:9], v[24:25] op_sel:[1,0,0] op_sel_hi:[0,0,1] neg_lo:[1,0,0]
  v_pk_fma_f32 v[68:69], v[70:71], v[6:7], v[68:69] op_sel:[1,0,0] op_sel_hi:[0,0,1] neg_lo:[1,0,0]
  v_pk_mul_f32 v[26:27], v[24:25], v[20:21] op_sel:[0,0] op_sel_hi:[1,0]
  v_cvt_pk_f16_f32 v73, v70, -v71
  v_pk_fma_f32 v[26:27], v[24:25], v[8:9], v[26:27] op_sel:[1,0,0] op_sel_hi:[0,0,1] neg_lo:[1,0,0]
  ds_write2_b32 v166, v72, v73 offset0:0 offset1:68
  v_pk_mul_f32 v[28:29], v[26:27], v[20:21] op_sel:[0,0] op_sel_hi:[1,0]
  v_pk_mul_f32 v[70:71], v[68:69], v[18:19] op_sel:[0,0] op_sel_hi:[1,0]
  v_pk_fma_f32 v[28:29], v[26:27], v[8:9], v[28:29] op_sel:[1,0,0] op_sel_hi:[0,0,1] neg_lo:[1,0,0]
  v_pk_fma_f32 v[70:71], v[68:69], v[6:7], v[70:71] op_sel:[1,0,0] op_sel_hi:[0,0,1] neg_lo:[1,0,0]
  v_pk_mul_f32 v[30:31], v[28:29], v[20:21] op_sel:[0,0] op_sel_hi:[1,0]
  v_cvt_pk_f16_f32 v72, v68, -v69
  v_pk_fma_f32 v[30:31], v[28:29], v[8:9], v[30:31] op_sel:[1,0,0] op_sel_hi:[0,0,1] neg_lo:[1,0,0]
  v_pk_mul_f32 v[68:69], v[70:71], v[18:19] op_sel:[0,0] op_sel_hi:[1,0]
  v_pk_mul_f32 v[32:33], v[30:31], v[20:21] op_sel:[0,0] op_sel_hi:[1,0]
  v_pk_fma_f32 v[68:69], v[70:71], v[6:7], v[68:69] op_sel:[1,0,0] op_sel_hi:[0,0,1] neg_lo:[1,0,0]
  v_pk_fma_f32 v[32:33], v[30:31], v[8:9], v[32:33] op_sel:[1,0,0] op_sel_hi:[0,0,1] neg_lo:[1,0,0]
  v_cvt_pk_f16_f32 v73, v70, -v71
  v_pk_mul_f32 v[34:35], v[32:33], v[20:21] op_sel:[0,0] op_sel_hi:[1,0]
  ds_write2_b32 v166, v72, v73 offset0:136 offset1:204
  v_pk_fma_f32 v[34:35], v[32:33], v[8:9], v[34:35] op_sel:[1,0,0] op_sel_hi:[0,0,1] neg_lo:[1,0,0]
  v_pk_mul_f32 v[70:71], v[68:69], v[18:19] op_sel:[0,0] op_sel_hi:[1,0]
  v_mov_b32 v10, v23
  v_pk_fma_f32 v[70:71], v[68:69], v[6:7], v[70:71] op_sel:[1,0,0] op_sel_hi:[0,0,1] neg_lo:[1,0,0]
  v_mov_b32 v12, v25
  v_cvt_pk_f16_f32 v72, v68, -v69
  v_mov_b32 v14, v53
  v_pk_mul_f32 v[68:69], v[70:71], v[18:19] op_sel:[0,0] op_sel_hi:[1,0]
  v_pk_fma_f32 v[68:69], v[70:71], v[6:7], v[68:69] op_sel:[1,0,0] op_sel_hi:[0,0,1] neg_lo:[1,0,0]
  v_cvt_pk_f16_f32 v73, v70, -v71
  ds_write2_b32 v167, v72, v73 offset0:0 offset1:68
  v_pk_mul_f32 v[70:71], v[68:69], v[18:19] op_sel:[0,0] op_sel_hi:[1,0]
  v_pk_fma_f32 v[70:71], v[68:69], v[6:7], v[70:71] op_sel:[1,0,0] op_sel_hi:[0,0,1] neg_lo:[1,0,0]
  v_cvt_pk_f16_f32 v72, v68, -v69
  v_cvt_pk_f16_f32 v73, v70, -v71
  ds_write2_b32 v167, v72, v73 offset0:136 offset1:204
  ds_read_b128 v[76:79], v75 offset:0
  ds_read_b128 v[80:83], v75 offset:64
  ds_read_b128 v[84:87], v75 offset:128
  ds_read_b128 v[88:91], v75 offset:192
  v_cvt_pk_f16_f32 v72, v36, v37
  v_cvt_pk_f16_f32 v73, v38, v39
  ds_write2_b32 v164, v72, v73 offset0:0 offset1:68
  v_cvt_pk_f16_f32 v72, v40, v41
  v_cvt_pk_f16_f32 v73, v42, v43
  ds_write2_b32 v164, v72, v73 offset0:136 offset1:204
  v_cvt_pk_f16_f32 v72, v44, v45
  v_cvt_pk_f16_f32 v73, v46, v47
  ds_write2_b32 v165, v72, v73 offset0:0 offset1:68
  v_cvt_pk_f16_f32 v72, v48, v49
  v_cvt_pk_f16_f32 v73, v50, v51
  ds_write2_b32 v165, v72, v73 offset0:136 offset1:204
  v_cvt_pk_f16_f32 v72, v52, v53
  v_cvt_pk_f16_f32 v73, v54, v55
  ds_write2_b32 v166, v72, v73 offset0:0 offset1:68
  v_cvt_pk_f16_f32 v72, v56, v57
  v_cvt_pk_f16_f32 v73, v58, v59
  ds_write2_b32 v166, v72, v73 offset0:136 offset1:204
  v_cvt_pk_f16_f32 v72, v60, v61
  v_cvt_pk_f16_f32 v73, v62, v63
  ds_write2_b32 v167, v72, v73 offset0:0 offset1:68
  v_cvt_pk_f16_f32 v72, v64, v65
  v_cvt_pk_f16_f32 v73, v66, v67
  ds_write2_b32 v167, v72, v73 offset0:136 offset1:204
  ds_read_b128 v[92:95], v75 offset:0
  ds_read_b128 v[96:99], v75 offset:64
  ds_read_b128 v[100:103], v75 offset:128
  ds_read_b128 v[104:107], v75 offset:192
  v_pk_mul_f32 v[68:69], v[20:21], v[36:37] op_sel:[0,0] op_sel_hi:[1,0]
  v_pk_mul_f32 v[70:71], v[44:45], v[20:21] op_sel:[0,0] op_sel_hi:[1,0]
  v_pk_fma_f32 v[70:71], v[44:45], v[8:9], v[70:71] op_sel:[1,0,0] op_sel_hi:[0,0,1] neg_lo:[1,0,0]
  v_cvt_pk_f16_f32 v72, v68, v69
  v_cvt_pk_f16_f32 v73, v70, v71
  ds_write2_b32 v164, v72, v73 offset0:0 offset1:68
  v_pk_mul_f32 v[68:69], v[52:53], v[20:21] op_sel:[0,0] op_sel_hi:[1,0]
  v_pk_mul_f32 v[70:71], v[60:61], v[20:21] op_sel:[0,0] op_sel_hi:[1,0]
  v_pk_fma_f32 v[68:69], v[52:53], v[8:9], v[68:69] op_sel:[1,0,0] op_sel_hi:[0,0,1] neg_lo:[1,0,0]
  v_pk_fma_f32 v[70:71], v[60:61], v[8:9], v[70:71] op_sel:[1,0,0] op_sel_hi:[0,0,1] neg_lo:[1,0,0]
  v_cvt_pk_f16_f32 v72, v68, v69
  v_cvt_pk_f16_f32 v73, v70, v71
  ds_write2_b32 v164, v72, v73 offset0:136 offset1:204
  v_pk_mul_f32 v[68:69], v[40:41], v[20:21] op_sel:[0,0] op_sel_hi:[1,0]
  v_pk_mul_f32 v[70:71], v[48:49], v[20:21] op_sel:[0,0] op_sel_hi:[1,0]
  v_pk_fma_f32 v[68:69], v[40:41], v[8:9], v[68:69] op_sel:[1,0,0] op_sel_hi:[0,0,1] neg_lo:[1,0,0]
  v_pk_fma_f32 v[70:71], v[48:49], v[8:9], v[70:71] op_sel:[1,0,0] op_sel_hi:[0,0,1] neg_lo:[1,0,0]
  v_cvt_pk_f16_f32 v72, v68, v69
  v_cvt_pk_f16_f32 v73, v70, v71
  ds_write2_b32 v165, v72, v73 offset0:0 offset1:68
  v_pk_mul_f32 v[68:69], v[56:57], v[20:21] op_sel:[0,0] op_sel_hi:[1,0]
  v_pk_mul_f32 v[70:71], v[64:65], v[20:21] op_sel:[0,0] op_sel_hi:[1,0]
  v_pk_fma_f32 v[68:69], v[56:57], v[8:9], v[68:69] op_sel:[1,0,0] op_sel_hi:[0,0,1] neg_lo:[1,0,0]
  v_pk_fma_f32 v[70:71], v[64:65], v[8:9], v[70:71] op_sel:[1,0,0] op_sel_hi:[0,0,1] neg_lo:[1,0,0]
  v_cvt_pk_f16_f32 v72, v68, v69
  v_cvt_pk_f16_f32 v73, v70, v71
  ds_write2_b32 v165, v72, v73 offset0:136 offset1:204
  v_pk_mul_f32 v[68:69], v[22:23], v[36:37] op_sel:[0,0] op_sel_hi:[1,0]
  v_pk_mul_f32 v[70:71], v[44:45], v[22:23] op_sel:[0,0] op_sel_hi:[1,0]
  v_pk_fma_f32 v[70:71], v[44:45], v[10:11], v[70:71] op_sel:[1,0,0] op_sel_hi:[0,0,1] neg_lo:[1,0,0]
  v_cvt_pk_f16_f32 v72, v68, v69
  v_cvt_pk_f16_f32 v73, v70, v71
  ds_write2_b32 v166, v72, v73 offset0:0 offset1:68
  v_pk_mul_f32 v[68:69], v[52:53], v[22:23] op_sel:[0,0] op_sel_hi:[1,0]
  v_pk_mul_f32 v[70:71], v[60:61], v[22:23] op_sel:[0,0] op_sel_hi:[1,0]
  v_pk_fma_f32 v[68:69], v[52:53], v[10:11], v[68:69] op_sel:[1,0,0] op_sel_hi:[0,0,1] neg_lo:[1,0,0]
  v_pk_fma_f32 v[70:71], v[60:61], v[10:11], v[70:71] op_sel:[1,0,0] op_sel_hi:[0,0,1] neg_lo:[1,0,0]
  v_cvt_pk_f16_f32 v72, v68, v69
  v_cvt_pk_f16_f32 v73, v70, v71
  ds_write2_b32 v166, v72, v73 offset0:136 offset1:204
  v_pk_mul_f32 v[68:69], v[24:25], v[36:37] op_sel:[0,0] op_sel_hi:[1,0]
  v_pk_mul_f32 v[70:71], v[44:45], v[24:25] op_sel:[0,0] op_sel_hi:[1,0]
  v_pk_fma_f32 v[70:71], v[44:45], v[12:13], v[70:71] op_sel:[1,0,0] op_sel_hi:[0,0,1] neg_lo:[1,0,0]
  v_cvt_pk_f16_f32 v72, v68, v69
  v_cvt_pk_f16_f32 v73, v70, v71
  ds_write2_b32 v167, v72, v73 offset0:0 offset1:68
  v_pk_mul_f32 v[68:69], v[52:53], v[24:25] op_sel:[0,0] op_sel_hi:[1,0]
  v_pk_mul_f32 v[70:71], v[60:61], v[24:25] op_sel:[0,0] op_sel_hi:[1,0]
  v_pk_fma_f32 v[68:69], v[52:53], v[12:13], v[68:69] op_sel:[1,0,0] op_sel_hi:[0,0,1] neg_lo:[1,0,0]
  v_pk_fma_f32 v[70:71], v[60:61], v[12:13], v[70:71] op_sel:[1,0,0] op_sel_hi:[0,0,1] neg_lo:[1,0,0]
  v_cvt_pk_f16_f32 v72, v68, v69
  v_cvt_pk_f16_f32 v73, v70, v71
  ds_write2_b32 v167, v72, v73 offset0:136 offset1:204
  ds_read_b128 v[144:147], v75 offset:0
  ds_read_b128 v[148:151], v75 offset:64
  ds_read_b128 v[152:155], v75 offset:128
  ds_read_b128 v[156:159], v75 offset:192
  s_waitcnt lgkmcnt(12)
  v_mfma_f32_16x16x32_f16 v[108:111], v[92:95], v[76:79], 0
  v_pk_mul_f32 v[68:69], v[26:27], v[36:37] op_sel:[0,0] op_sel_hi:[1,0]
  v_pk_mul_f32 v[70:71], v[28:29], v[36:37] op_sel:[0,0] op_sel_hi:[1,0]
  v_cvt_pk_f16_f32 v72, v68, v69
  v_mfma_f32_16x16x32_f16 v[108:111], v[96:99], v[80:83], v[108:111]
  v_cvt_pk_f16_f32 v73, v70, v71
  ds_write2_b32 v164, v72, v73 offset0:0 offset1:68
  v_pk_mul_f32 v[68:69], v[30:31], v[36:37] op_sel:[0,0] op_sel_hi:[1,0]
  v_mfma_f32_16x16x32_f16 v[108:111], v[100:103], v[84:87], v[108:111]
  v_pk_mul_f32 v[70:71], v[32:33], v[36:37] op_sel:[0,0] op_sel_hi:[1,0]
  v_cvt_pk_f16_f32 v72, v68, v69
  v_cvt_pk_f16_f32 v73, v70, v71
  v_mfma_f32_16x16x32_f16 v[108:111], v[104:107], v[88:91], v[108:111]
  ds_write2_b32 v164, v72, v73 offset0:136 offset1:204
  v_pk_mul_f32 v[68:69], v[26:27], v[52:53] op_sel:[0,0] op_sel_hi:[1,0]
  v_pk_mul_f32 v[70:71], v[28:29], v[52:53] op_sel:[0,0] op_sel_hi:[1,0]
  v_pk_fma_f32 v[68:69], v[26:27], v[14:15], v[68:69] op_sel:[1,0,0] op_sel_hi:[0,0,1] neg_lo:[1,0,0]
  v_pk_fma_f32 v[70:71], v[28:29], v[14:15], v[70:71] op_sel:[1,0,0] op_sel_hi:[0,0,1] neg_lo:[1,0,0]
  v_cvt_pk_f16_f32 v72, v68, v69
  v_cvt_pk_f16_f32 v73, v70, v71
  ds_write2_b32 v165, v72, v73 offset0:0 offset1:68
  v_pk_mul_f32 v[68:69], v[30:31], v[52:53] op_sel:[0,0] op_sel_hi:[1,0]
  v_pk_mul_f32 v[70:71], v[32:33], v[52:53] op_sel:[0,0] op_sel_hi:[1,0]
  v_pk_fma_f32 v[68:69], v[30:31], v[14:15], v[68:69] op_sel:[1,0,0] op_sel_hi:[0,0,1] neg_lo:[1,0,0]
  v_pk_fma_f32 v[70:71], v[32:33], v[14:15], v[70:71] op_sel:[1,0,0] op_sel_hi:[0,0,1] neg_lo:[1,0,0]
  v_cvt_pk_f16_f32 v72, v68, v69
  v_cvt_pk_f16_f32 v73, v70, v71
  ds_write2_b32 v165, v72, v73 offset0:136 offset1:204
  v_pk_mul_f32 v[68:69], v[34:35], v[36:37] op_sel:[0,0] op_sel_hi:[1,0]
  v_cvt_pk_f16_f32 v72, v68, v69
  ds_write_b32 v166, v72
  ds_read_b128 v[92:95], v75 offset:0
  ds_read_b128 v[96:99], v75 offset:64
  ds_read_b128 v[100:103], v75 offset:128
  ds_read_b128 v[104:107], v75 offset:192
  s_waitcnt lgkmcnt(9)
  v_mfma_f32_16x16x32_f16 v[112:115], v[144:147], v[76:79], 0
  v_mfma_f32_16x16x32_f16 v[112:115], v[148:151], v[80:83], v[112:115]
  v_mfma_f32_16x16x32_f16 v[112:115], v[152:155], v[84:87], v[112:115]
  v_mfma_f32_16x16x32_f16 v[112:115], v[156:159], v[88:91], v[112:115]
  v_ldexp_f32 v108, v108, s24
  v_ldexp_f32 v109, v109, s24
  v_ldexp_f32 v110, v110, s24
  v_ldexp_f32 v111, v111, s24
  s_waitcnt lgkmcnt(0)
  v_mfma_f32_16x16x32_f16 v[116:119], v[92:95], v[76:79], 0
  v_mfma_f32_16x16x32_f16 v[116:119], v[96:99], v[80:83], v[116:119]
  v_mfma_f32_16x16x32_f16 v[116:119], v[100:103], v[84:87], v[116:119]
  v_mfma_f32_16x16x32_f16 v[116:119], v[104:107], v[88:91], v[116:119]
  ds_write_b32 v120, v108 offset:0
  ds_write_b32 v120, v109 offset:4
  ds_write_b32 v120, v110 offset:8
  ds_write_b32 v120, v111 offset:12
  v_ldexp_f32 v112, v112, s24
  v_ldexp_f32 v113, v113, s24
  v_ldexp_f32 v114, v114, s24
  v_ldexp_f32 v115, v115, s24
  ds_write_b32 v121, v112 offset:0
  ds_write_b32 v121, v113 offset:16
  ds_write_b32 v121, v114 offset:32
  ds_write_b32 v121, v115 offset:48
  v_ldexp_f32 v116, v116, s24
  v_ldexp_f32 v117, v117, s24
  v_ldexp_f32 v118, v118, s24
  v_ldexp_f32 v119, v119, s24
  s_mov_b32 exec_hi, 1
  ds_write_b32 v122, v116 offset:4352
  s_mov_b32 exec_hi, 0
  ds_write_b32 v122, v117 offset:5440
  ds_write_b32 v122, v118 offset:6528
  ds_write_b32 v122, v119 offset:7616
  s_mov_b32 exec_hi, -1
  v_add_u32 v3, 4476, v2
  v_mov_b32 v111, 0
  s_waitcnt vmcnt(0)
  global_load_dword v112, v111, s[50:51] sc1
  v_mov_b32 v80, 105728
  v_mov_b32 v81, 1
  s_waitcnt lgkmcnt(0)
  s_mov_b64 exec, 1
  ds_add_u32 v80, v81 offset:20
  s_mov_b64 exec, -1
  s_mov_b32 s46, 2097152
K1_LT:
  ds_read_b32 v81, v80 offset:20
  s_sub_u32 s46, s46, 1
  s_waitcnt lgkmcnt(0)
  v_readfirstlane_b32 s45, v81
  s_nop 1
  s_cmp_eq_u32 s45, 4
  s_cbranch_scc1 K1_XT
  s_cmp_lg_u32 s46, 0
  s_cbranch_scc1 K1_LT
K1_XT:
  s_cmp_ge_u32 s33, 2
  s_cbranch_scc1 K0_G1
  ds_read_b32 v36, v124 offset:8768
  ds_read_b32 v124, v124 offset:0
  ds_read_b32 v37, v125 offset:8768
  ds_read_b32 v125, v125 offset:0
  ds_read_b32 v38, v126 offset:8768
  ds_read_b32 v126, v126 offset:0
  ds_read_b32 v39, v127 offset:8768
  ds_read_b32 v127, v127 offset:0
  ds_read_b32 v40, v128 offset:8768
  ds_read_b32 v128, v128 offset:0
  ds_read_b32 v41, v129 offset:8768
  ds_read_b32 v129, v129 offset:0
  ds_read_b32 v42, v130 offset:8768
  ds_read_b32 v130, v130 offset:0
  ds_read_b32 v43, v131 offset:8768
  ds_read_b32 v131, v131 offset:0
  ds_read_b32 v44, v132 offset:8768
  ds_read_b32 v132, v132 offset:0
  ds_read_b32 v45, v133 offset:8768
  ds_read_b32 v133, v133 offset:0
  ds_read_b32 v46, v134 offset:8768
  ds_read_b32 v134, v134 offset:0
  ds_read_b32 v47, v135 offset:8768
  ds_read_b32 v135, v135 offset:0
  ds_read_b32 v48, v136 offset:8768
  ds_read_b32 v136, v136 offset:0
  ds_read_b32 v49, v137 offset:8768
  ds_read_b32 v137, v137 offset:0
  ds_read_b32 v50, v138 offset:8768
  ds_read_b32 v138, v138 offset:0
  ds_read_b32 v51, v139 offset:8768
  ds_read_b32 v139, v139 offset:0
  s_branch K0_G2
K0_G1:
  ds_read_b32 v36, v124 offset:26304
  ds_read_b32 v124, v124 offset:17536
  ds_read_b32 v37, v125 offset:26304
  ds_read_b32 v125, v125 offset:17536
  ds_read_b32 v38, v126 offset:26304
  ds_read_b32 v126, v126 offset:17536
  ds_read_b32 v39, v127 offset:26304
  ds_read_b32 v127, v127 offset:17536
  ds_read_b32 v40, v128 offset:26304
  ds_read_b32 v128, v128 offset:17536
  ds_read_b32 v41, v129 offset:26304
  ds_read_b32 v129, v129 offset:17536
  ds_read_b32 v42, v130 offset:26304
  ds_read_b32 v130, v130 offset:17536
  ds_read_b32 v43, v131 offset:26304
  ds_read_b32 v131, v131 offset:17536
  ds_read_b32 v44, v132 offset:26304
  ds_read_b32 v132, v132 offset:17536
  ds_read_b32 v45, v133 offset:26304
  ds_read_b32 v133, v133 offset:17536
  ds_read_b32 v46, v134 offset:26304
  ds_read_b32 v134, v134 offset:17536
  ds_read_b32 v47, v135 offset:26304
  ds_read_b32 v135, v135 offset:17536
  ds_read_b32 v48, v136 offset:26304
  ds_read_b32 v136, v136 offset:17536
  ds_read_b32 v49, v137 offset:26304
  ds_read_b32 v137, v137 offset:17536
  ds_read_b32 v50, v138 offset:26304
  ds_read_b32 v138, v138 offset:17536
  ds_read_b32 v51, v139 offset:26304
  ds_read_b32 v139, v139 offset:17536
K0_G2:
  s_waitcnt lgkmcnt(14)
  v_pk_add_f32 v[124:125], v[124:125], v[36:37] op_sel:[0,0] op_sel_hi:[1,1]
  v_pk_add_f32 v[126:127], v[126:127], v[38:39] op_sel:[0,0] op_sel_hi:[1,1]
  v_pk_add_f32 v[128:129], v[128:129], v[40:41] op_sel:[0,0] op_sel_hi:[1,1]
  v_pk_add_f32 v[130:131], v[130:131], v[42:43] op_sel:[0,0] op_sel_hi:[1,1]
  v_cvt_pk_bf16_f32 v56, v124, v125
  v_cvt_pk_bf16_f32 v57, v126, v127
  v_cvt_pk_bf16_f32 v58, v128, v129
  v_cvt_pk_bf16_f32 v59, v130, v131
  ds_write_b128 v2, v[56:59] offset:256
  ds_write2_b32 v3, v56, v57 offset0:0 offset1:1
  ds_write2_b32 v3, v58, v59 offset0:2 offset1:3
  s_waitcnt lgkmcnt(0)
  v_pk_add_f32 v[132:133], v[132:133], v[44:45] op_sel:[0,0] op_sel_hi:[1,1]
  v_pk_add_f32 v[134:135], v[134:135], v[46:47] op_sel:[0,0] op_sel_hi:[1,1]
  v_pk_add_f32 v[136:137], v[136:137], v[48:49] op_sel:[0,0] op_sel_hi:[1,1]
  v_pk_add_f32 v[138:139], v[138:139], v[50:51] op_sel:[0,0] op_sel_hi:[1,1]
  v_cvt_pk_bf16_f32 v60, v132, v133
  v_cvt_pk_bf16_f32 v61, v134, v135
  v_cvt_pk_bf16_f32 v62, v136, v137
  v_cvt_pk_bf16_f32 v63, v138, v139
  ds_write_b128 v2, v[60:63] offset:2304
  v_add_u32 v3, 2048, v3
  ds_write2_b32 v3, v60, v61 offset0:0 offset1:1
  ds_write2_b32 v3, v62, v63 offset0:2 offset1:3
  s_waitcnt lgkmcnt(0)
  v_lshrrev_b32 v61, 2, v0
  v_and_b32 v3, 3, v0
  v_lshlrev_b32 v2, 14, v61
  v_lshl_add_u32 v2, v3, 4, v2
  v_bfe_u32 v3, v0, 1, 1
  s_lshl_b32 s7, s6, 5
  s_add_u32 s7, s7, 0x300000
  s_add_u32 s10, s4, s7
  s_addc_u32 s11, s5, 0
  s_add_u32 s12, s10, 0x100000
  s_addc_u32 s13, s11, 0
  s_add_u32 s24, s4, 0x50000
  s_addc_u32 s25, s5, 0
  s_mov_b32 s26, 16384
  s_mov_b32 s27, 0x20000
  v_and_b32 v63, 1, v0
  v_lshlrev_b32 v61, 4, v61
  v_lshl_add_u32 v61, v63, 3, v61
  v_lshlrev_b32 v40, 4, v1
  s_lshl_b32 s28, s33, 11
  s_mul_i32 s29, s33, 9216
  s_add_u32 s29, s29, 40192
  v_lshrrev_b32 v42, 2, v1
  v_lshlrev_b32 v42, 7, v42
  v_lshl_add_u32 v42, v63, 5, v42
  v_add_u32 v42, s29, v42
  v_mov_b32 v39, 105728
  v_mov_b32 v48, 1
  s_lshr_b32 s35, s33, 1
  s_and_b32 s36, s33, 1
  s_mul_i32 s34, s33, 4224
  s_add_u32 s34, s34, 256
  v_min_u32 v51, 34, v0
  v_lshlrev_b32 v51, 4, v51
  v_pk_mov_b32 v[52:53], 0, 0
  v_pk_mov_b32 v[54:55], 0, 0
  ds_write_b128 v51, v[52:55] offset:17152
  ds_write_b128 v51, v[52:55] offset:22912
  ds_write_b128 v51, v[52:55] offset:28672
  ds_write_b128 v51, v[52:55] offset:34432
  v_mul_u32_u24 v51, 11520, v3
  ds_write_b16 v51, v52 offset:23472
  v_and_b32 v46, 15, v1
  v_lshl_add_u32 v46, v46, 3, s34
  ds_write_b64 v46, v[52:53] offset:4096
  v_mul_u32_u24 v46, 8448, v3
  ds_write_b32 v46, v52 offset:8572
  v_lshrrev_b32 v60, 5, v61
  v_lshl_add_u32 v54, v61, 1, v51
  v_lshl_add_u32 v54, v60, 4, v54
  v_add_u32 v55, 8, v61
  v_lshrrev_b32 v55, 5, v55
  v_sub_u32 v55, v55, v60
  v_lshl_add_u32 v55, v55, 4, v54
  v_and_b32 v58, 1, v1
  v_bfe_u32 v59, v1, 1, 3
  v_lshrrev_b32 v50, 4, v1
  s_mul_i32 s37, s35, 8448
  s_lshl_b32 s38, s36, 8
  s_sub_u32 s37, s37, s38
  s_add_u32 s37, s37, 568
  v_xor_b32 v38, 1, v58
  v_mul_u32_u24 v56, 4224, v38
  v_sub_u32 v37, v50, v59
  v_lshl_add_u32 v56, v37, 3, v56
  v_add_u32 v56, s37, v56
  s_mul_i32 s37, s35, 11520
  s_mul_i32 s38, s36, 320
  s_sub_u32 s37, s37, s38
  s_add_u32 s37, s37, 17472
  v_mul_u32_u24 v57, 5760, v58
  v_lshl_add_u32 v57, v50, 3, v57
  v_mul_u32_u24 v37, 80, v59
  v_add3_u32 v57, v57, v37, s37
  s_waitcnt lgkmcnt(0)
  s_mov_b64 exec, 1
  ds_add_u32 v39, v48 offset:32
  s_mov_b64 exec, -1
  s_cmp_lg_u32 s33, 0
  s_cbranch_scc1 K1_GW
  s_mov_b32 s46, 131072
  s_waitcnt vmcnt(0)
K1_P1:
  v_readfirstlane_b32 s47, v112
  s_nop 1
  s_cmp_lg_u32 s47, 0
  s_cbranch_scc1 K1_P1X
  global_load_dword v112, v111, s[50:51] sc1
  s_sub_u32 s46, s46, 1
  s_cmp_lg_u32 s46, 0
  s_waitcnt vmcnt(0)
  s_cbranch_scc1 K1_P1
K1_P1X:
  ds_write_b32 v39, v112 offset:52
  s_add_u32 s22, s4, 0x5a000
  s_addc_u32 s23, s5, 0
  v_lshlrev_b32 v113, 7, v1
  s_mov_b32 exec_hi, 0
  s_mov_b32 s46, 131072
  s_sleep 4
K1_P3:
  global_load_dwordx4 v[116:119], v113, s[22:23] sc1
  s_waitcnt vmcnt(0)
K1_P4:
  v_xor_b32 v116, v116, v112
  v_xor_b32 v117, v117, v112
  v_xor_b32 v118, v118, v112
  v_xor_b32 v119, v119, v112
  v_or3_b32 v116, v116, v117, v118
  v_or_b32 v116, v116, v119
  v_cmp_ne_u32 vcc, 0, v116
  s_nop 1
  s_cmp_eq_u64 vcc, 0
  s_cbranch_scc1 K1_GO
  s_mov_b64 exec, vcc
  s_sleep 4
  s_sub_u32 s46, s46, 1
  s_cmp_lg_u32 s46, 0
  s_cbranch_scc1 K1_P3
K1_GO:
  s_mov_b64 exec, 1
  ds_add_u32 v39, v48 offset:32
  s_mov_b64 exec, -1
K1_GW:
  s_mov_b32 s46, 2097152
K1_LA:
  ds_read_b32 v49, v39 offset:32
  s_sub_u32 s46, s46, 1
  s_waitcnt lgkmcnt(0)
  v_readfirstlane_b32 s45, v49
  s_nop 1
  s_cmp_eq_u32 s45, 5
  s_cbranch_scc1 K1_XA
  s_sleep 1
  s_cmp_lg_u32 s46, 0
  s_cbranch_scc1 K1_LA
K1_XA:
  global_load_dwordx4 v[4:7], v2, s[10:11] sc1
  global_load_dwordx4 v[8:11], v2, s[12:13] sc1
  s_mov_b32 m0, s29
  s_nop 0
  buffer_load_dwordx4 v40, s[24:27], s28 offen offset:0 sc1 lds
  buffer_load_dwordx4 v40, s[24:27], s28 offen offset:1024 sc1 lds
  s_add_u32 m0, s29, 2048
  s_add_u32 s28, s28, 8192
  buffer_load_dwordx4 v40, s[24:27], s28 offen offset:0 sc1 lds
  buffer_load_dwordx4 v40, s[24:27], s28 offen offset:1024 sc1 lds
  s_mov_b64 exec, 1
  ds_add_u32 v39, v48 offset:44
  s_mov_b64 exec, -1
  v_mov_b32 v64, v131
  v_mov_b32 v72, v139
  v_add_f32 v65, v64, v130
  v_add_f32 v73, v72, v138
  v_add_f32 v66, v65, v129
  v_add_f32 v74, v73, v137
  v_add_f32 v67, v66, v128
  v_add_f32 v75, v74, v136
  v_add_f32 v68, v67, v127
  v_add_f32 v76, v75, v135
  v_add_f32 v69, v68, v126
  v_add_f32 v77, v76, v134
  v_add_f32 v70, v69, v125
  v_add_f32 v78, v77, v133
  v_add_f32 v71, v70, v124
  v_add_f32 v79, v78, v132
  v_mov_b32 v80, v71
  v_mov_b32 v82, v79
  s_nop 0
  v_add_f32_dpp v80, v80, v80 row_shr:1 row_mask:0xf bank_mask:0xf
  v_add_f32_dpp v82, v82, v82 row_shr:1 row_mask:0xf bank_mask:0xf
  s_nop 0
  v_add_f32_dpp v80, v80, v80 row_shr:2 row_mask:0xf bank_mask:0xf
  v_add_f32_dpp v82, v82, v82 row_shr:2 row_mask:0xf bank_mask:0xf
  s_nop 0
  v_add_f32_dpp v80, v80, v80 row_shr:4 row_mask:0xf bank_mask:0xf
  v_add_f32_dpp v82, v82, v82 row_shr:4 row_mask:0xf bank_mask:0xf
  s_nop 0
  v_add_f32_dpp v80, v80, v80 row_shr:8 row_mask:0xf bank_mask:0xf
  v_add_f32_dpp v82, v82, v82 row_shr:8 row_mask:0xf bank_mask:0xf
  s_nop 0
  v_add_f32_dpp v80, v80, v80 row_bcast:15 row_mask:0xa bank_mask:0xf
  v_add_f32_dpp v82, v82, v82 row_bcast:15 row_mask:0xa bank_mask:0xf
  s_nop 0
  v_add_f32_dpp v80, v80, v80 row_bcast:31 row_mask:0xc bank_mask:0xf
  v_add_f32_dpp v82, v82, v82 row_bcast:31 row_mask:0xc bank_mask:0xf
  v_readlane_b32 s40, v80, 63
  v_readlane_b32 s41, v82, 63
  v_lshrrev_b32 v88, 7, v0
  v_lshlrev_b32 v84, 13, v88
  v_lshlrev_b32 v85, 1, v161
  v_sub_u32 v84, v84, v85
  v_add_u32 v84, 109920, v84
  v_sub_f32 v80, s40, v80
  v_sub_f32 v82, s41, v82
  s_and_b32 s42, s33, 1
  s_xor_b32 s42, s42, 1
  s_lshl_b32 s42, s42, 2
  s_add_u32 s42, s42, 122240
  v_lshl_add_u32 v85, v88, 4, s42
  v_mov_b32 v86, s41
  v_mov_b32 v87, s40
  v_pk_add_f32 v[64:65], v[64:65], v[80:81] op_sel:[0,0] op_sel_hi:[1,0]
  v_pk_add_f32 v[66:67], v[66:67], v[80:81] op_sel:[0,0] op_sel_hi:[1,0]
  v_pk_add_f32 v[68:69], v[68:69], v[80:81] op_sel:[0,0] op_sel_hi:[1,0]
  v_pk_add_f32 v[70:71], v[70:71], v[80:81] op_sel:[0,0] op_sel_hi:[1,0]
  ds_write_b128 v84, v[64:67] offset:4096
  ds_write_b128 v84, v[68:71] offset:4112
  v_pk_add_f32 v[72:73], v[72:73], v[82:83] op_sel:[0,0] op_sel_hi:[1,0]
  v_pk_add_f32 v[74:75], v[74:75], v[82:83] op_sel:[0,0] op_sel_hi:[1,0]
  v_pk_add_f32 v[76:77], v[76:77], v[82:83] op_sel:[0,0] op_sel_hi:[1,0]
  v_pk_add_f32 v[78:79], v[78:79], v[82:83] op_sel:[0,0] op_sel_hi:[1,0]
  ds_write_b128 v84, v[72:75] offset:0
  ds_write_b128 v84, v[76:79] offset:16
  ds_write2_b32 v85, v86, v87 offset0:0 offset1:2
  s_waitcnt vmcnt(0)
  ds_read_b128 v[96:99], v42 offset:0
  ds_read_b128 v[100:103], v42 offset:16
  ds_read_b128 v[112:115], v42 offset:64
  ds_read_b128 v[116:119], v42 offset:80
  ds_read_b128 v[104:107], v42 offset:2048
  ds_read_b128 v[108:111], v42 offset:2064
  ds_read_b128 v[120:123], v42 offset:2112
  ds_read_b128 v[124:127], v42 offset:2128
  v_lshlrev_b32 v176, 16, v4
  v_and_b32 v177, 0xffff0000, v4
  v_lshlrev_b32 v178, 16, v5
  v_and_b32 v179, 0xffff0000, v5
  v_lshlrev_b32 v180, 16, v6
  v_and_b32 v181, 0xffff0000, v6
  v_lshlrev_b32 v182, 16, v7
  v_and_b32 v183, 0xffff0000, v7
  s_waitcnt lgkmcnt(0)
  v_pk_fma_f32 v[160:161], v[176:177], v[96:97], v[112:113] op_sel:[0,0,0] op_sel_hi:[1,1,1]
  v_pk_fma_f32 v[162:163], v[178:179], v[98:99], v[114:115] op_sel:[0,0,0] op_sel_hi:[1,1,1]
  v_pk_fma_f32 v[164:165], v[180:181], v[100:101], v[116:117] op_sel:[0,0,0] op_sel_hi:[1,1,1]
  v_pk_fma_f32 v[166:167], v[182:183], v[102:103], v[118:119] op_sel:[0,0,0] op_sel_hi:[1,1,1]
  v_cvt_pk_bf16_f32 v40, v160, v161
  v_cvt_pk_bf16_f32 v41, v162, v163
  v_cvt_pk_bf16_f32 v42, v164, v165
  v_cvt_pk_bf16_f32 v43, v166, v167
  ds_write_b128 v54, v[40:43] offset:17712
  v_cvt_pk_bf16_f32 v5, v161, v162
  v_cvt_pk_bf16_f32 v6, v163, v164
  v_cvt_pk_bf16_f32 v7, v165, v166
  ds_write_b16 v54, v40 offset:23474
  ds_write_b16_d16_hi v55, v43 offset:23488
  ds_write_b32 v54, v5 offset:23476
  ds_write_b64 v54, v[6:7] offset:23480
  v_lshlrev_b32 v184, 16, v8
  v_and_b32 v185, 0xffff0000, v8
  v_lshlrev_b32 v186, 16, v9
  v_and_b32 v187, 0xffff0000, v9
  v_lshlrev_b32 v188, 16, v10
  v_and_b32 v189, 0xffff0000, v10
  v_lshlrev_b32 v190, 16, v11
  v_and_b32 v191, 0xffff0000, v11
  v_pk_fma_f32 v[168:169], v[184:185], v[104:105], v[120:121] op_sel:[0,0,0] op_sel_hi:[1,1,1]
  v_pk_fma_f32 v[170:171], v[186:187], v[106:107], v[122:123] op_sel:[0,0,0] op_sel_hi:[1,1,1]
  v_pk_fma_f32 v[172:173], v[188:189], v[108:109], v[124:125] op_sel:[0,0,0] op_sel_hi:[1,1,1]
  v_pk_fma_f32 v[174:175], v[190:191], v[110:111], v[126:127] op_sel:[0,0,0] op_sel_hi:[1,1,1]
  v_cvt_pk_bf16_f32 v44, v168, v169
  v_cvt_pk_bf16_f32 v45, v170, v171
  v_cvt_pk_bf16_f32 v46, v172, v173
  v_cvt_pk_bf16_f32 v47, v174, v175
  ds_write_b128 v54, v[44:47] offset:20272
  v_cvt_pk_bf16_f32 v9, v169, v170
  v_cvt_pk_bf16_f32 v10, v171, v172
  v_cvt_pk_bf16_f32 v11, v173, v174
  ds_write_b16 v54, v44 offset:26034
  ds_write_b16_d16_hi v55, v47 offset:26048
  ds_write_b32 v54, v9 offset:26036
  ds_write_b64 v54, v[10:11] offset:26040
  s_waitcnt lgkmcnt(0)
  s_mov_b64 exec, 1
  ds_add_u32 v39, v48 offset:8
  s_mov_b64 exec, -1
  s_mov_b32 s46, 2097152
K1_LH:
  ds_read_b32 v48, v39 offset:8
  s_sub_u32 s46, s46, 1
  s_waitcnt lgkmcnt(0)
  v_readfirstlane_b32 s45, v48
  s_nop 1
  s_cmp_eq_u32 s45, 4
  s_cbranch_scc1 K1_XH
  s_cmp_lg_u32 s46, 0
  s_cbranch_scc1 K1_LH
K1_XH:
  ds_read_b64 v[128:129], v57 offset:240
  ds_read_b64 v[130:131], v57 offset:272
  ds_read_b64 v[96:97], v56 offset:3776
  ds_read_b64 v[98:99], v56 offset:3808
  ds_read_b64 v[132:133], v57 offset:880
  ds_read_b64 v[134:135], v57 offset:912
  ds_read_b64 v[100:101], v56 offset:3264
  ds_read_b64 v[102:103], v56 offset:3296
  ds_read_b64 v[136:137], v57 offset:1520
  ds_read_b64 v[138:139], v57 offset:1552
  ds_read_b64 v[104:105], v56 offset:2752
  ds_read_b64 v[106:107], v56 offset:2784
  ds_read_b64 v[140:141], v57 offset:2160
  ds_read_b64 v[142:143], v57 offset:2192
  ds_read_b64 v[108:109], v56 offset:2240
  ds_read_b64 v[110:111], v56 offset:2272
  ds_read_b64 v[144:145], v57 offset:2800
  ds_read_b64 v[146:147], v57 offset:2832
  ds_read_b64 v[112:113], v56 offset:1728
  ds_read_b64 v[114:115], v56 offset:1760
  ds_read_b64 v[148:149], v57 offset:3440
  ds_read_b64 v[150:151], v57 offset:3472
  ds_read_b64 v[116:117], v56 offset:1216
  ds_read_b64 v[118:119], v56 offset:1248
  ds_read_b64 v[152:153], v57 offset:4080
  ds_read_b64 v[154:155], v57 offset:4112
  ds_read_b64 v[120:121], v56 offset:704
  ds_read_b64 v[122:123], v56 offset:736
  ds_read_b64 v[156:157], v57 offset:4720
  ds_read_b64 v[158:159], v57 offset:4752
  ds_read_b64 v[124:125], v56 offset:192
  ds_read_b64 v[126:127], v56 offset:224
  s_waitcnt lgkmcnt(14)
  v_mfma_f32_16x16x32_bf16 v[64:67], v[96:99], v[128:131], 0
  ds_read_b64 v[224:225], v57 offset:160
  s_mul_i32 s37, s33, 9216
  v_mfma_f32_16x16x32_bf16 v[72:75], v[100:103], v[132:135], 0
  ds_read_b64 v[226:227], v57 offset:192
  s_add_u32 s37, s37, 40192
  v_mfma_f32_16x16x32_bf16 v[68:71], v[96:99], v[132:135], 0
  ds_read_b64 v[192:193], v56 offset:3712
  v_mul_u32_u24 v62, 144, v59
  v_mfma_f32_16x16x32_bf16 v[72:75], v[96:99], v[136:139], v[72:75]
  ds_read_b64 v[194:195], v56 offset:3744
  v_lshl_add_u32 v62, v50, 5, v62
  v_mfma_f32_16x16x32_bf16 v[68:71], v[100:103], v[128:131], v[68:71]
  ds_read_b64 v[228:229], v57 offset:800
  v_lshl_add_u32 v62, v38, 2, v62
  v_mfma_f32_16x16x32_bf16 v[72:75], v[104:107], v[128:131], v[72:75]
  ds_read_b64 v[230:231], v57 offset:832
  v_add_u32 v62, s37, v62
  v_mfma_f32_16x16x32_bf16 v[80:83], v[104:107], v[136:139], 0
  ds_read_b64 v[196:197], v56 offset:3200
  v_lshl_add_u32 v63, v60, 2, v61
  v_mfma_f32_16x16x32_bf16 v[76:79], v[100:103], v[136:139], 0
  ds_read_b64 v[198:199], v56 offset:3232
  v_mul_u32_u24 v58, 18432, v3
  v_mfma_f32_16x16x32_bf16 v[80:83], v[100:103], v[140:143], v[80:83]
  ds_read_b64 v[232:233], v57 offset:1440
  v_lshl_add_u32 v63, v63, 2, v58
  v_mfma_f32_16x16x32_bf16 v[76:79], v[104:107], v[132:135], v[76:79]
  ds_read_b64 v[234:235], v57 offset:1472
  v_add_u32 v63, 40192, v63
  v_mfma_f32_16x16x32_bf16 v[80:83], v[108:111], v[132:135], v[80:83]
  ds_read_b64 v[200:201], v56 offset:2688
  v_add_u32 v37, s6, v3
  v_mfma_f32_16x16x32_bf16 v[88:91], v[108:111], v[140:143], 0
  ds_read_b64 v[202:203], v56 offset:2720
  v_lshrrev_b32 v2, 7, v61
  v_mfma_f32_16x16x32_bf16 v[76:79], v[96:99], v[140:143], v[76:79]
  ds_read_b64 v[236:237], v57 offset:2080
  v_lshlrev_b32 v2, 17, v2
  v_mfma_f32_16x16x32_bf16 v[84:87], v[104:107], v[140:143], 0
  ds_read_b64 v[238:239], v57 offset:2112
  v_lshl_add_u32 v2, v37, 8, v2
  v_mfma_f32_16x16x32_bf16 v[76:79], v[108:111], v[128:131], v[76:79]
  v_and_b32 v58, 127, v61
  v_mfma_f32_16x16x32_bf16 v[84:87], v[108:111], v[136:139], v[84:87]
  v_and_b32 v59, 3, v37
  s_waitcnt lgkmcnt(14)
  v_mfma_f32_16x16x32_bf16 v[80:83], v[96:99], v[144:147], v[80:83]
  ds_read_b64 v[204:205], v56 offset:2176
  v_lshlrev_b32 v59, 5, v59
  v_mfma_f32_16x16x32_bf16 v[88:91], v[104:107], v[144:147], v[88:91]
  ds_read_b64 v[206:207], v56 offset:2208
  v_xor_b32 v58, v58, v59
  v_mfma_f32_16x16x32_bf16 v[80:83], v[112:115], v[128:131], v[80:83]
  ds_read_b64 v[240:241], v57 offset:2720
  v_bfe_u32 v59, v37, 3, 1
  v_mfma_f32_16x16x32_bf16 v[88:91], v[112:115], v[136:139], v[88:91]
  ds_read_b64 v[242:243], v57 offset:2752
  v_lshlrev_b32 v59, 4, v59
  v_mfma_f32_16x16x32_bf16 v[84:87], v[100:103], v[144:147], v[84:87]
  ds_read_b64 v[208:209], v56 offset:1664
  v_xor_b32 v58, v58, v59
  v_mfma_f32_16x16x32_bf16 v[92:95], v[108:111], v[144:147], 0
  ds_read_b64 v[210:211], v56 offset:1696
  v_lshl_add_u32 v2, v58, 1, v2
  v_mfma_f32_16x16x32_bf16 v[84:87], v[112:115], v[132:135], v[84:87]
  ds_read_b64 v[244:245], v57 offset:3360
  v_lshlrev_b32 v36, 13, v3
  v_mfma_f32_16x16x32_bf16 v[92:95], v[112:115], v[140:143], v[92:95]
  ds_read_b64 v[246:247], v57 offset:3392
  v_lshl_add_u32 v36, v61, 2, v36
  v_mfma_f32_16x16x32_bf16 v[88:91], v[100:103], v[148:151], v[88:91]
  ds_read_b64 v[212:213], v56 offset:1152
  v_add_u32 v36, 105856, v36
  v_mfma_f32_16x16x32_bf16 v[84:87], v[96:99], v[148:151], v[84:87]
  ds_read_b64 v[214:215], v56 offset:1184
  v_lshlrev_b32 v38, 4, v3
  v_mfma_f32_16x16x32_bf16 v[88:91], v[116:119], v[132:135], v[88:91]
  ds_read_b64 v[248:249], v57 offset:4000
  v_add_u32 v38, 105792, v38
  v_mfma_f32_16x16x32_bf16 v[92:95], v[104:107], v[148:151], v[92:95]
  ds_read_b64 v[250:251], v57 offset:4032
  s_add_u32 s10, s4, 0xa00000
  v_mfma_f32_16x16x32_bf16 v[84:87], v[116:119], v[128:131], v[84:87]
  ds_read_b64 v[216:217], v56 offset:640
  s_addc_u32 s11, s5, 0
  v_mfma_f32_16x16x32_bf16 v[92:95], v[116:119], v[136:139], v[92:95]
  ds_read_b64 v[218:219], v56 offset:672
  s_add_u32 s12, s4, 0xb00000
  v_mfma_f32_16x16x32_bf16 v[88:91], v[96:99], v[152:155], v[88:91]
  ds_read_b64 v[252:253], v57 offset:4640
  s_addc_u32 s13, s5, 0
  v_mfma_f32_16x16x32_bf16 v[92:95], v[100:103], v[152:155], v[92:95]
  ds_read_b64 v[254:255], v57 offset:4672
  v_mfma_f32_16x16x32_bf16 v[88:91], v[120:123], v[128:131], v[88:91]
  ds_read_b64 v[220:221], v56 offset:128
  v_mfma_f32_16x16x32_bf16 v[92:95], v[120:123], v[132:135], v[92:95]
  ds_read_b64 v[222:223], v56 offset:160
  v_mfma_f32_16x16x32_bf16 v[92:95], v[96:99], v[156:159], v[92:95]
  v_mfma_f32_16x16x32_bf16 v[92:95], v[124:127], v[128:131], v[92:95]
  s_waitcnt lgkmcnt(0)
  v_mfma_f32_16x16x32_bf16 v[64:67], v[192:195], v[224:227], v[64:67]
  ds_read_b64 v[128:129], v57 offset:80
  v_mfma_f32_16x16x32_bf16 v[72:75], v[196:199], v[228:231], v[72:75]
  ds_read_b64 v[130:131], v57 offset:112
  v_mfma_f32_16x16x32_bf16 v[68:71], v[192:195], v[228:231], v[68:71]
  ds_read_b64 v[96:97], v56 offset:3648
  v_mfma_f32_16x16x32_bf16 v[72:75], v[192:195], v[232:235], v[72:75]
  ds_read_b64 v[98:99], v56 offset:3680
  v_mfma_f32_16x16x32_bf16 v[68:71], v[196:199], v[224:227], v[68:71]
  ds_read_b64 v[132:133], v57 offset:720
  v_mfma_f32_16x16x32_bf16 v[72:75], v[200:203], v[224:227], v[72:75]
  ds_read_b64 v[134:135], v57 offset:752
  v_mfma_f32_16x16x32_bf16 v[80:83], v[200:203], v[232:235], v[80:83]
  ds_read_b64 v[100:101], v56 offset:3136
  v_mfma_f32_16x16x32_bf16 v[76:79], v[196:199], v[232:235], v[76:79]
  ds_read_b64 v[102:103], v56 offset:3168
  v_mfma_f32_16x16x32_bf16 v[80:83], v[196:199], v[236:239], v[80:83]
  ds_read_b64 v[136:137], v57 offset:1360
  v_mfma_f32_16x16x32_bf16 v[76:79], v[200:203], v[228:231], v[76:79]
  ds_read_b64 v[138:139], v57 offset:1392
  v_mfma_f32_16x16x32_bf16 v[80:83], v[204:207], v[228:231], v[80:83]
  ds_read_b64 v[104:105], v56 offset:2624
  v_mfma_f32_16x16x32_bf16 v[88:91], v[204:207], v[236:239], v[88:91]
  ds_read_b64 v[106:107], v56 offset:2656
  v_mfma_f32_16x16x32_bf16 v[76:79], v[192:195], v[236:239], v[76:79]
  ds_read_b64 v[140:141], v57 offset:2000
  v_mfma_f32_16x16x32_bf16 v[84:87], v[200:203], v[236:239], v[84:87]
  ds_read_b64 v[142:143], v57 offset:2032
  v_mfma_f32_16x16x32_bf16 v[76:79], v[204:207], v[224:227], v[76:79]
  ds_read_b64 v[108:109], v56 offset:2112
  v_mfma_f32_16x16x32_bf16 v[84:87], v[204:207], v[232:235], v[84:87]
  ds_read_b64 v[110:111], v56 offset:2144
  v_mfma_f32_16x16x32_bf16 v[80:83], v[192:195], v[240:243], v[80:83]
  ds_read_b64 v[144:145], v57 offset:2640
  v_mfma_f32_16x16x32_bf16 v[88:91], v[200:203], v[240:243], v[88:91]
  ds_read_b64 v[146:147], v57 offset:2672
  v_mfma_f32_16x16x32_bf16 v[80:83], v[208:211], v[224:227], v[80:83]
  ds_read_b64 v[112:113], v56 offset:1600
  v_mfma_f32_16x16x32_bf16 v[88:91], v[208:211], v[232:235], v[88:91]
  ds_read_b64 v[114:115], v56 offset:1632
  v_mfma_f32_16x16x32_bf16 v[84:87], v[196:199], v[240:243], v[84:87]
  ds_read_b64 v[148:149], v57 offset:3280
  v_mfma_f32_16x16x32_bf16 v[92:95], v[204:207], v[240:243], v[92:95]
  ds_read_b64 v[150:151], v57 offset:3312
  v_mfma_f32_16x16x32_bf16 v[84:87], v[208:211], v[228:231], v[84:87]
  ds_read_b64 v[116:117], v56 offset:1088
  v_mfma_f32_16x16x32_bf16 v[92:95], v[208:211], v[236:239], v[92:95]
  ds_read_b64 v[118:119], v56 offset:1120
  v_mfma_f32_16x16x32_bf16 v[88:91], v[196:199], v[244:247], v[88:91]
  ds_read_b64 v[152:153], v57 offset:3920
  v_mfma_f32_16x16x32_bf16 v[84:87], v[192:195], v[244:247], v[84:87]
  ds_read_b64 v[154:155], v57 offset:3952
  v_mfma_f32_16x16x32_bf16 v[88:91], v[212:215], v[228:231], v[88:91]
  ds_read_b64 v[120:121], v56 offset:576
  v_mfma_f32_16x16x32_bf16 v[92:95], v[200:203], v[244:247], v[92:95]
  ds_read_b64 v[122:123], v56 offset:608
  v_mfma_f32_16x16x32_bf16 v[84:87], v[212:215], v[224:227], v[84:87]
  ds_read_b64 v[156:157], v57 offset:4560
  v_mfma_f32_16x16x32_bf16 v[92:95], v[212:215], v[232:235], v[92:95]
  ds_read_b64 v[158:159], v57 offset:4592
  v_mfma_f32_16x16x32_bf16 v[88:91], v[192:195], v[248:251], v[88:91]
  ds_read_b64 v[124:125], v56 offset:64
  v_mfma_f32_16x16x32_bf16 v[92:95], v[196:199], v[248:251], v[92:95]
  ds_read_b64 v[126:127], v56 offset:96
  v_mfma_f32_16x16x32_bf16 v[88:91], v[216:219], v[224:227], v[88:91]
  v_mfma_f32_16x16x32_bf16 v[92:95], v[216:219], v[228:231], v[92:95]
  v_mfma_f32_16x16x32_bf16 v[92:95], v[192:195], v[252:255], v[92:95]
  v_mfma_f32_16x16x32_bf16 v[92:95], v[220:223], v[224:227], v[92:95]
  s_waitcnt lgkmcnt(0)
  v_mfma_f32_16x16x32_bf16 v[64:67], v[96:99], v[128:131], v[64:67]
  ds_read_b64 v[224:225], v57 offset:0
  v_mfma_f32_16x16x32_bf16 v[72:75], v[100:103], v[132:135], v[72:75]
  ds_read_b64 v[226:227], v57 offset:32
  v_mfma_f32_16x16x32_bf16 v[68:71], v[96:99], v[132:135], v[68:71]
  ds_read_b64 v[192:193], v56 offset:3584
  v_mfma_f32_16x16x32_bf16 v[72:75], v[96:99], v[136:139], v[72:75]
  ds_read_b64 v[194:195], v56 offset:3616
  v_mfma_f32_16x16x32_bf16 v[68:71], v[100:103], v[128:131], v[68:71]
  ds_read_b64 v[228:229], v57 offset:640
  v_mfma_f32_16x16x32_bf16 v[72:75], v[104:107], v[128:131], v[72:75]
  ds_read_b64 v[230:231], v57 offset:672
  v_mfma_f32_16x16x32_bf16 v[80:83], v[104:107], v[136:139], v[80:83]
  ds_read_b64 v[196:197], v56 offset:3072
  v_mfma_f32_16x16x32_bf16 v[76:79], v[100:103], v[136:139], v[76:79]
  ds_read_b64 v[198:199], v56 offset:3104
  v_mfma_f32_16x16x32_bf16 v[80:83], v[100:103], v[140:143], v[80:83]
  ds_read_b64 v[232:233], v57 offset:1280
  v_mfma_f32_16x16x32_bf16 v[76:79], v[104:107], v[132:135], v[76:79]
  ds_read_b64 v[234:235], v57 offset:1312
  v_mfma_f32_16x16x32_bf16 v[80:83], v[108:111], v[132:135], v[80:83]
  ds_read_b64 v[200:201], v56 offset:2560
  v_mfma_f32_16x16x32_bf16 v[88:91], v[108:111], v[140:143], v[88:91]
  ds_read_b64 v[202:203], v56 offset:2592
  v_mfma_f32_16x16x32_bf16 v[76:79], v[96:99], v[140:143], v[76:79]
  ds_read_b64 v[236:237], v57 offset:1920
  v_mfma_f32_16x16x32_bf16 v[84:87], v[104:107], v[140:143], v[84:87]
  ds_read_b64 v[238:239], v57 offset:1952
  v_mfma_f32_16x16x32_bf16 v[76:79], v[108:111], v[128:131], v[76:79]
  ds_read_b64 v[204:205], v56 offset:2048
  v_mfma_f32_16x16x32_bf16 v[84:87], v[108:111], v[136:139], v[84:87]
  ds_read_b64 v[206:207], v56 offset:2080
  v_mfma_f32_16x16x32_bf16 v[80:83], v[96:99], v[144:147], v[80:83]
  ds_read_b64 v[240:241], v57 offset:2560
  v_mfma_f32_16x16x32_bf16 v[88:91], v[104:107], v[144:147], v[88:91]
  ds_read_b64 v[242:243], v57 offset:2592
  v_mfma_f32_16x16x32_bf16 v[80:83], v[112:115], v[128:131], v[80:83]
  ds_read_b64 v[208:209], v56 offset:1536
  v_mfma_f32_16x16x32_bf16 v[88:91], v[112:115], v[136:139], v[88:91]
  ds_read_b64 v[210:211], v56 offset:1568
  v_mfma_f32_16x16x32_bf16 v[84:87], v[100:103], v[144:147], v[84:87]
  ds_read_b64 v[244:245], v57 offset:3200
  v_mfma_f32_16x16x32_bf16 v[92:95], v[108:111], v[144:147], v[92:95]
  ds_read_b64 v[246:247], v57 offset:3232
  v_mfma_f32_16x16x32_bf16 v[84:87], v[112:115], v[132:135], v[84:87]
  ds_read_b64 v[212:213], v56 offset:1024
  v_mfma_f32_16x16x32_bf16 v[92:95], v[112:115], v[140:143], v[92:95]
  ds_read_b64 v[214:215], v56 offset:1056
  v_mfma_f32_16x16x32_bf16 v[88:91], v[100:103], v[148:151], v[88:91]
  ds_read_b64 v[248:249], v57 offset:3840
  v_mfma_f32_16x16x32_bf16 v[84:87], v[96:99], v[148:151], v[84:87]
  ds_read_b64 v[250:251], v57 offset:3872
  v_mfma_f32_16x16x32_bf16 v[88:91], v[116:119], v[132:135], v[88:91]
  ds_read_b64 v[216:217], v56 offset:512
  v_mfma_f32_16x16x32_bf16 v[92:95], v[104:107], v[148:151], v[92:95]
  ds_read_b64 v[218:219], v56 offset:544
  v_mfma_f32_16x16x32_bf16 v[84:87], v[116:119], v[128:131], v[84:87]
  ds_read_b64 v[252:253], v57 offset:4480
  v_mfma_f32_16x16x32_bf16 v[92:95], v[116:119], v[136:139], v[92:95]
  ds_read_b64 v[254:255], v57 offset:4512
  v_mfma_f32_16x16x32_bf16 v[88:91], v[96:99], v[152:155], v[88:91]
  ds_read_b64 v[220:221], v56 offset:0
  v_mfma_f32_16x16x32_bf16 v[92:95], v[100:103], v[152:155], v[92:95]
  ds_read_b64 v[222:223], v56 offset:32
  v_mfma_f32_16x16x32_bf16 v[88:91], v[120:123], v[128:131], v[88:91]
  v_mfma_f32_16x16x32_bf16 v[92:95], v[120:123], v[132:135], v[92:95]
  v_mfma_f32_16x16x32_bf16 v[92:95], v[96:99], v[156:159], v[92:95]
  v_mfma_f32_16x16x32_bf16 v[92:95], v[124:127], v[128:131], v[92:95]
  s_waitcnt lgkmcnt(0)
  v_mfma_f32_16x16x32_bf16 v[64:67], v[192:195], v[224:227], v[64:67]
  ds_read_b128 v[96:99], v36 offset:0
  v_mfma_f32_16x16x32_bf16 v[72:75], v[196:199], v[228:231], v[72:75]
  ds_read_b128 v[100:103], v36 offset:16
  v_mfma_f32_16x16x32_bf16 v[68:71], v[192:195], v[228:231], v[68:71]
  ds_read_b128 v[104:107], v36 offset:4096
  v_mfma_f32_16x16x32_bf16 v[72:75], v[192:195], v[232:235], v[72:75]
  ds_read_b128 v[108:111], v36 offset:4112
  v_mfma_f32_16x16x32_bf16 v[68:71], v[196:199], v[224:227], v[68:71]
  ds_read_b128 v[112:115], v38 offset:16448
  v_mfma_f32_16x16x32_bf16 v[72:75], v[200:203], v[224:227], v[72:75]
  v_mfma_f32_16x16x32_bf16 v[80:83], v[200:203], v[232:235], v[80:83]
  v_mfma_f32_16x16x32_bf16 v[76:79], v[196:199], v[232:235], v[76:79]
  v_mfma_f32_16x16x32_bf16 v[80:83], v[196:199], v[236:239], v[80:83]
  v_mfma_f32_16x16x32_bf16 v[76:79], v[200:203], v[228:231], v[76:79]
  v_mfma_f32_16x16x32_bf16 v[80:83], v[204:207], v[228:231], v[80:83]
  v_mfma_f32_16x16x32_bf16 v[88:91], v[204:207], v[236:239], v[88:91]
  v_mfma_f32_16x16x32_bf16 v[76:79], v[192:195], v[236:239], v[76:79]
  v_mfma_f32_16x16x32_bf16 v[84:87], v[200:203], v[236:239], v[84:87]
  v_mfma_f32_16x16x32_bf16 v[76:79], v[204:207], v[224:227], v[76:79]
  v_mfma_f32_16x16x32_bf16 v[84:87], v[204:207], v[232:235], v[84:87]
  v_mfma_f32_16x16x32_bf16 v[80:83], v[192:195], v[240:243], v[80:83]
  v_mfma_f32_16x16x32_bf16 v[88:91], v[200:203], v[240:243], v[88:91]
  v_mfma_f32_16x16x32_bf16 v[80:83], v[208:211], v[224:227], v[80:83]
  v_mfma_f32_16x16x32_bf16 v[88:91], v[208:211], v[232:235], v[88:91]
  v_mfma_f32_16x16x32_bf16 v[84:87], v[196:199], v[240:243], v[84:87]
  v_mfma_f32_16x16x32_bf16 v[92:95], v[204:207], v[240:243], v[92:95]
  v_mfma_f32_16x16x32_bf16 v[84:87], v[208:211], v[228:231], v[84:87]
  v_mfma_f32_16x16x32_bf16 v[92:95], v[208:211], v[236:239], v[92:95]
  v_mfma_f32_16x16x32_bf16 v[88:91], v[196:199], v[244:247], v[88:91]
  v_mfma_f32_16x16x32_bf16 v[84:87], v[192:195], v[244:247], v[84:87]
  v_mfma_f32_16x16x32_bf16 v[88:91], v[212:215], v[228:231], v[88:91]
  v_mfma_f32_16x16x32_bf16 v[92:95], v[200:203], v[244:247], v[92:95]
  v_mfma_f32_16x16x32_bf16 v[84:87], v[212:215], v[224:227], v[84:87]
  v_mfma_f32_16x16x32_bf16 v[92:95], v[212:215], v[232:235], v[92:95]
  v_mfma_f32_16x16x32_bf16 v[88:91], v[192:195], v[248:251], v[88:91]
  v_mfma_f32_16x16x32_bf16 v[92:95], v[196:199], v[248:251], v[92:95]
  v_mfma_f32_16x16x32_bf16 v[88:91], v[216:219], v[224:227], v[88:91]
  v_mfma_f32_16x16x32_bf16 v[92:95], v[216:219], v[228:231], v[92:95]
  v_mfma_f32_16x16x32_bf16 v[92:95], v[192:195], v[252:255], v[92:95]
  v_mfma_f32_16x16x32_bf16 v[92:95], v[220:223], v[224:227], v[92:95]
  ds_write2_b32 v62, v64, v65 offset0:0 offset1:2
  ds_write2_b32 v62, v66, v67 offset0:4 offset1:6
  v_add_u32 v62, 1152, v62
  ds_write2_b32 v62, v68, v69 offset0:0 offset1:2
  ds_write2_b32 v62, v70, v71 offset0:4 offset1:6
  v_add_u32 v62, 1152, v62
  ds_write2_b32 v62, v72, v73 offset0:0 offset1:2
  ds_write2_b32 v62, v74, v75 offset0:4 offset1:6
  v_add_u32 v62, 1152, v62
  ds_write2_b32 v62, v76, v77 offset0:0 offset1:2
  ds_write2_b32 v62, v78, v79 offset0:4 offset1:6
  v_add_u32 v62, 1152, v62
  ds_write2_b32 v62, v80, v81 offset0:0 offset1:2
  ds_write2_b32 v62, v82, v83 offset0:4 offset1:6
  v_add_u32 v62, 1152, v62
  ds_write2_b32 v62, v84, v85 offset0:0 offset1:2
  ds_write2_b32 v62, v86, v87 offset0:4 offset1:6
  v_add_u32 v62, 1152, v62
  ds_write2_b32 v62, v88, v89 offset0:0 offset1:2
  ds_write2_b32 v62, v90, v91 offset0:4 offset1:6
  v_add_u32 v62, 1152, v62
  ds_write2_b32 v62, v92, v93 offset0:0 offset1:2
  ds_write2_b32 v62, v94, v95 offset0:4 offset1:6
  v_mov_b32 v48, 1
  s_waitcnt lgkmcnt(0)
  s_mov_b64 exec, 1
  ds_add_u32 v39, v48 offset:36
  s_mov_b64 exec, -1
  s_mov_b32 s46, 2097152
K1_LM:
  ds_read_b32 v48, v39 offset:12
  s_sub_u32 s46, s46, 1
  s_waitcnt lgkmcnt(0)
  v_readfirstlane_b32 s45, v48
  s_nop 1
  s_cmp_eq_u32 s45, 1
  s_cbranch_scc1 K1_XM
  s_sleep 1
  s_cmp_lg_u32 s46, 0
  s_cbranch_scc1 K1_LM
K1_XM:
  ds_read_b128 v[20:23], v38
  s_cmp_ge_u32 s33, 2
  s_cselect_b32 s40, 1.0, 0
  v_mul_f32 v24, s40, v112
  v_add_f32 v26, v112, v113
  v_fma_f32 v26, s40, v114, v26
  s_waitcnt lgkmcnt(0)
  v_fma_f32 v24, v24, v22, v23
  v_fma_f32 v26, v26, v22, v23
  v_pk_fma_f32 v[160:161], v[20:21], v[160:161], v[176:177] op_sel:[1,0,0] op_sel_hi:[1,1,1]
  v_pk_fma_f32 v[96:97], v[96:97], v[22:23], v[24:25] op_sel:[0,0,0] op_sel_hi:[1,0,0]
  v_pk_fma_f32 v[162:163], v[20:21], v[162:163], v[178:179] op_sel:[1,0,0] op_sel_hi:[1,1,1]
  v_pk_fma_f32 v[98:99], v[98:99], v[22:23], v[24:25] op_sel:[0,0,0] op_sel_hi:[1,0,0]
  v_pk_fma_f32 v[164:165], v[20:21], v[164:165], v[180:181] op_sel:[1,0,0] op_sel_hi:[1,1,1]
  v_pk_fma_f32 v[100:101], v[100:101], v[22:23], v[24:25] op_sel:[0,0,0] op_sel_hi:[1,0,0]
  v_pk_fma_f32 v[166:167], v[20:21], v[166:167], v[182:183] op_sel:[1,0,0] op_sel_hi:[1,1,1]
  v_pk_fma_f32 v[102:103], v[102:103], v[22:23], v[24:25] op_sel:[0,0,0] op_sel_hi:[1,0,0]
  v_pk_fma_f32 v[168:169], v[20:21], v[168:169], v[184:185] op_sel:[1,0,0] op_sel_hi:[1,1,1]
  v_pk_fma_f32 v[104:105], v[104:105], v[22:23], v[26:27] op_sel:[0,0,0] op_sel_hi:[1,0,0]
  v_pk_fma_f32 v[170:171], v[20:21], v[170:171], v[186:187] op_sel:[1,0,0] op_sel_hi:[1,1,1]
  v_pk_fma_f32 v[106:107], v[106:107], v[22:23], v[26:27] op_sel:[0,0,0] op_sel_hi:[1,0,0]
  v_pk_fma_f32 v[172:173], v[20:21], v[172:173], v[188:189] op_sel:[1,0,0] op_sel_hi:[1,1,1]
  v_pk_fma_f32 v[108:109], v[108:109], v[22:23], v[26:27] op_sel:[0,0,0] op_sel_hi:[1,0,0]
  v_pk_fma_f32 v[174:175], v[20:21], v[174:175], v[190:191] op_sel:[1,0,0] op_sel_hi:[1,1,1]
  v_pk_fma_f32 v[110:111], v[110:111], v[22:23], v[26:27] op_sel:[0,0,0] op_sel_hi:[1,0,0]
  v_pk_add_f32 v[160:161], v[160:161], v[96:97] op_sel:[0,0] op_sel_hi:[1,1]
  v_pk_add_f32 v[162:163], v[162:163], v[98:99] op_sel:[0,0] op_sel_hi:[1,1]
  v_pk_add_f32 v[164:165], v[164:165], v[100:101] op_sel:[0,0] op_sel_hi:[1,1]
  v_pk_add_f32 v[166:167], v[166:167], v[102:103] op_sel:[0,0] op_sel_hi:[1,1]
  v_pk_add_f32 v[168:169], v[168:169], v[104:105] op_sel:[0,0] op_sel_hi:[1,1]
  v_pk_add_f32 v[170:171], v[170:171], v[106:107] op_sel:[0,0] op_sel_hi:[1,1]
  v_pk_add_f32 v[172:173], v[172:173], v[108:109] op_sel:[0,0] op_sel_hi:[1,1]
  v_pk_add_f32 v[174:175], v[174:175], v[110:111] op_sel:[0,0] op_sel_hi:[1,1]
  s_mov_b32 s46, 2097152
K1_LP:
  ds_read_b32 v48, v39 offset:36
  s_sub_u32 s46, s46, 1
  s_waitcnt lgkmcnt(0)
  v_readfirstlane_b32 s45, v48
  s_nop 1
  s_cmp_eq_u32 s45, 4
  s_cbranch_scc1 K1_XP
  s_cmp_lg_u32 s46, 0
  s_cbranch_scc1 K1_LP
K1_XP:
  ds_read_b128 v[64:67], v63 offset:0
  ds_read_b128 v[68:71], v63 offset:16
  ds_read_b128 v[72:75], v63 offset:9216
  ds_read_b128 v[76:79], v63 offset:9232
  ds_read_b128 v[80:83], v63 offset:4608
  ds_read_b128 v[84:87], v63 offset:4624
  ds_read_b128 v[88:91], v63 offset:13824
  ds_read_b128 v[92:95], v63 offset:13840
  s_waitcnt lgkmcnt(4)
  v_pk_add_f32 v[64:65], v[64:65], v[72:73] op_sel:[0,0] op_sel_hi:[1,1]
  v_pk_add_f32 v[66:67], v[66:67], v[74:75] op_sel:[0,0] op_sel_hi:[1,1]
  v_pk_add_f32 v[68:69], v[68:69], v[76:77] op_sel:[0,0] op_sel_hi:[1,1]
  v_pk_add_f32 v[70:71], v[70:71], v[78:79] op_sel:[0,0] op_sel_hi:[1,1]
  v_pk_fma_f32 v[64:65], v[64:65], v[20:21], v[160:161] op_sel:[0,0,0] op_sel_hi:[1,0,1]
  v_pk_fma_f32 v[66:67], v[66:67], v[20:21], v[162:163] op_sel:[0,0,0] op_sel_hi:[1,0,1]
  v_pk_fma_f32 v[68:69], v[68:69], v[20:21], v[164:165] op_sel:[0,0,0] op_sel_hi:[1,0,1]
  v_pk_fma_f32 v[70:71], v[70:71], v[20:21], v[166:167] op_sel:[0,0,0] op_sel_hi:[1,0,1]
  v_cvt_pk_bf16_f32 v116, v64, v65
  v_cvt_pk_bf16_f32 v117, v66, v67
  v_cvt_pk_bf16_f32 v118, v68, v69
  v_cvt_pk_bf16_f32 v119, v70, v71
  global_store_dwordx4 v2, v[116:119], s[10:11] sc1
  s_waitcnt lgkmcnt(0)
  v_pk_add_f32 v[80:81], v[80:81], v[88:89] op_sel:[0,0] op_sel_hi:[1,1]
  v_pk_add_f32 v[82:83], v[82:83], v[90:91] op_sel:[0,0] op_sel_hi:[1,1]
  v_pk_add_f32 v[84:85], v[84:85], v[92:93] op_sel:[0,0] op_sel_hi:[1,1]
  v_pk_add_f32 v[86:87], v[86:87], v[94:95] op_sel:[0,0] op_sel_hi:[1,1]
  v_pk_fma_f32 v[80:81], v[80:81], v[20:21], v[168:169] op_sel:[0,0,0] op_sel_hi:[1,0,1]
  v_pk_fma_f32 v[82:83], v[82:83], v[20:21], v[170:171] op_sel:[0,0,0] op_sel_hi:[1,0,1]
  v_pk_fma_f32 v[84:85], v[84:85], v[20:21], v[172:173] op_sel:[0,0,0] op_sel_hi:[1,0,1]
  v_pk_fma_f32 v[86:87], v[86:87], v[20:21], v[174:175] op_sel:[0,0,0] op_sel_hi:[1,0,1]
  v_cvt_pk_bf16_f32 v120, v80, v81
  v_cvt_pk_bf16_f32 v121, v82, v83
  v_cvt_pk_bf16_f32 v122, v84, v85
  v_cvt_pk_bf16_f32 v123, v86, v87
  global_store_dwordx4 v2, v[120:123], s[12:13] sc1
  s_endpgm
K1_B:
  s_setprio 3
  s_load_dwordx2 s[8:9], s[0:1], 0
  s_load_dwordx4 s[40:43], s[0:1], 104
  s_load_dwordx4 s[44:47], s[0:1], 80
  s_load_dwordx2 s[48:49], s[0:1], 96
  s_load_dwordx2 s[50:51], s[0:1], 128
  s_load_dwordx2 s[54:55], s[0:1], 64
  s_memrealtime s[52:53]
  v_and_b32 v0, 255, v0
  v_lshrrev_b32 v3, 6, v0
  v_mov_b32 v110, 105728
  v_mov_b32 v111, 0
  ds_write2_b32 v110, v111, v111 offset0:0 offset1:1
  ds_write2_b32 v110, v111, v111 offset0:2 offset1:3
  ds_write2_b32 v110, v111, v111 offset0:4 offset1:5
  ds_write2_b32 v110, v111, v111 offset0:6 offset1:7
  ds_write2_b32 v110, v111, v111 offset0:8 offset1:9
  ds_write2_b32 v110, v111, v111 offset0:10 offset1:11
  ds_write2_b32 v110, v111, v111 offset0:12 offset1:13
  s_cmp_ge_u32 s2, 128
  s_cbranch_scc1 K1_NOTXT
  s_lshl_b32 s6, s2, 14
  v_lshrrev_b32 v60, 4, v1
  v_lshlrev_b32 v61, 2, v60
  v_xor_b32 v61, v61, v1
  v_and_b32 v61, 15, v61
  v_lshlrev_b32 v61, 4, v61
  v_lshl_add_u32 v61, v60, 10, v61
  s_sub_u32 s30, s33, 4
  s_lshl_b32 s28, s30, 12
  s_add_u32 s28, s28, 77056
  s_lshl_b32 s29, s30, 8
  s_lshl_b32 s7, s2, 3
  s_add_u32 s7, s7, s33
  s_cmp_lg_u32 s7, 4
  s_waitcnt lgkmcnt(0)
  s_cbranch_scc1 K1_NOTAG
  s_or_b32 s52, s52, 1
  v_mov_b32 v114, s52
  global_store_dword v111, v114, s[50:51] sc1
K1_NOTAG:
  s_add_u32 s24, s8, s6
  s_addc_u32 s25, s9, 0
  s_mov_b32 s26, 16384
  s_mov_b32 s27, 0x20000
  s_add_u32 m0, s28, 0
  s_nop 0
  buffer_load_dwordx4 v61, s[24:27], s29 offen lds
  s_add_u32 s29, s29, 4096
  s_add_u32 m0, s28, 1024
  s_nop 0
  buffer_load_dwordx4 v61, s[24:27], s29 offen lds
  s_add_u32 s29, s29, 4096
  s_add_u32 m0, s28, 2048
  s_nop 0
  buffer_load_dwordx4 v61, s[24:27], s29 offen lds
  s_add_u32 s29, s29, 4096
  s_add_u32 m0, s28, 3072
  s_nop 0
  buffer_load_dwordx4 v61, s[24:27], s29 offen lds
  s_add_u32 s29, s29, 4096
  s_barrier
  v_bfe_u32 v62, v1, 2, 2
  v_and_b32 v63, 1, v60
  v_lshl_add_u32 v64, v63, 3, v62
  v_lshlrev_b32 v64, 8, v64
  v_lshrrev_b32 v65, 5, v1
  v_bfe_u32 v66, v1, 1, 1
  v_lshl_add_u32 v66, v65, 1, v66
  v_lshl_add_u32 v66, v62, 2, v66
  v_lshl_add_u32 v64, v66, 4, v64
  v_and_b32 v66, 1, v1
  v_lshl_add_u32 v64, v66, 3, v64
  v_add_u32 v64, s28, v64
  v_xor_b32 v89, 64, v64
  v_xor_b32 v90, 128, v64
  v_xor_b32 v91, 192, v64
  v_mov_b32 v88, v64
  v_and_b32 v66, 15, v1
  v_lshl_add_u32 v66, v65, 4, v66
  v_lshlrev_b32 v66, 5, v66
  v_lshl_add_u32 v65, v63, 4, v66
  s_lshl_b32 s7, s30, 12
  s_add_u32 s7, s7, s6
  s_add_u32 s7, s7, 0x300000
  s_add_u32 s10, s4, s7
  s_addc_u32 s11, s5, 0
  s_lshl_b32 s7, s2, 7
  s_add_u32 s7, s7, 0x50000
  s_add_u32 s16, s4, s7
  s_addc_u32 s17, s5, 0
  v_and_b32 v67, 15, v1
  v_and_b32 v68, 3, v1
  v_lshl_add_u32 v68, v68, 2, v60
  v_lshlrev_b32 v68, 4, v68
  v_lshl_add_u32 v68, v67, 8, v68
  v_add_u32 v68, s28, v68
  v_xor_b32 v69, 64, v68
  v_xor_b32 v70, 128, v68
  v_xor_b32 v71, 192, v68
  v_mov_b32 v20, 0x3f803f80
  v_mov_b32 v21, 0x3f803f80
  v_mov_b32 v22, 0x3f803f80
  v_mov_b32 v23, 0x3f803f80
  v_cmp_eq_u32 s[20:21], v60, v62
  v_and_b32 v72, 3, v1
  v_cmp_eq_u32 s[12:13], 1, v72
  v_cmp_eq_u32 s[14:15], 2, v72
  v_cmp_eq_u32 s[18:19], 3, v72
  v_lshlrev_b32 v72, 3, v67
  v_add_u32 v73, 122272, v72
  v_lshl_add_u32 v72, v3, 7, v73
  v_lshlrev_b32 v67, 2, v67
  s_setprio 3
  s_waitcnt vmcnt(0)
  ds_read_b64_tr_b16 v[92:93], v88 offset:0
  ds_read_b64_tr_b16 v[94:95], v88 offset:1024
  ds_read_b64_tr_b16 v[96:97], v89 offset:0
  ds_read_b64_tr_b16 v[98:99], v89 offset:1024
  ds_read_b64_tr_b16 v[100:101], v90 offset:0
  ds_read_b64_tr_b16 v[102:103], v90 offset:1024
  ds_read_b64_tr_b16 v[104:105], v91 offset:0
  ds_read_b64_tr_b16 v[106:107], v91 offset:1024
  ds_read_b128 v[4:7], v68
  ds_read_b128 v[8:11], v69
  ds_read_b128 v[12:15], v70
  ds_read_b128 v[16:19], v71
  s_waitcnt lgkmcnt(10)
  global_store_dwordx4 v65, v[92:95], s[10:11] offset:0 sc1
  s_waitcnt lgkmcnt(8)
  global_store_dwordx4 v65, v[96:99], s[10:11] offset:1024 sc1
  s_waitcnt lgkmcnt(6)
  global_store_dwordx4 v65, v[100:103], s[10:11] offset:2048 sc1
  s_waitcnt lgkmcnt(4)
  global_store_dwordx4 v65, v[104:107], s[10:11] offset:3072 sc1
  s_waitcnt lgkmcnt(3)
  v_mfma_f32_16x16x32_bf16 v[28:31], v[4:7], v[4:7], 0
  v_mfma_f32_16x16x32_bf16 v[24:27], v[20:23], v[4:7], 0
  s_waitcnt lgkmcnt(2)
  v_mfma_f32_16x16x32_bf16 v[28:31], v[8:11], v[8:11], v[28:31]
  v_mfma_f32_16x16x32_bf16 v[24:27], v[20:23], v[8:11], v[24:27]
  s_waitcnt lgkmcnt(1)
  v_mfma_f32_16x16x32_bf16 v[28:31], v[12:15], v[12:15], v[28:31]
  v_mfma_f32_16x16x32_bf16 v[24:27], v[20:23], v[12:15], v[24:27]
  s_waitcnt lgkmcnt(0)
  v_mfma_f32_16x16x32_bf16 v[28:31], v[16:19], v[16:19], v[28:31]
  v_mfma_f32_16x16x32_bf16 v[24:27], v[20:23], v[16:19], v[24:27]
  v_mov_b32 v113, 1
  s_nop 6
  v_cndmask_b32 v25, v28, v29, s[12:13]
  v_cndmask_b32 v25, v25, v30, s[14:15]
  v_cndmask_b32 v25, v25, v31, s[18:19]
  s_mov_b64 exec, s[20:21]
  ds_write_b64 v72, v[24:25]
  s_mov_b64 exec, 1
  ds_add_rtn_u32 v114, v110, v113 offset:24
  s_mov_b64 exec, -1
  s_waitcnt lgkmcnt(0)
  v_readfirstlane_b32 s35, v114
  s_nop 1
  s_cmp_lg_u32 s35, 3
  s_cbranch_scc1 K1_PUB
  ds_read_b64 v[52:53], v73 offset:0
  ds_read_b64 v[54:55], v73 offset:128
  ds_read_b64 v[56:57], v73 offset:256
  ds_read_b64 v[58:59], v73 offset:384
  s_mov_b32 s12, 0x3b000000
  s_waitcnt lgkmcnt(0)
  v_pk_add_f32 v[52:53], v[52:53], v[54:55] op_sel:[0,0] op_sel_hi:[1,1]
  v_pk_add_f32 v[56:57], v[56:57], v[58:59] op_sel:[0,0] op_sel_hi:[1,1]
  v_pk_add_f32 v[52:53], v[52:53], v[56:57] op_sel:[0,0] op_sel_hi:[1,1]
  v_pk_mul_f32 v[52:53], v[52:53], s[12:13] op_sel:[0,0] op_sel_hi:[1,0]
  v_fma_f32 v56, -v52, v52, v53
  v_max_f32 v56, 0, v56
  v_cvt_pk_bf16_f32 v53, v56, v52
  v_lshlrev_b32 v56, 16, v53
  v_and_b32 v52, 0xffff0000, v53
  v_add_f32 v56, 0x3727c5ac, v56
  v_cvt_pk_bf16_f32 v56, v56, v56
  v_lshlrev_b32 v56, 16, v56
  v_sqrt_f32 v56, v56
  s_nop 0
  v_cvt_pk_bf16_f32 v56, v56, v56
  v_lshlrev_b32 v56, 16, v56
  v_rcp_f32 v56, v56
  v_cmp_gt_u32 vcc, 16, v1
  v_lshlrev_b32 v67, 2, v1
  v_mul_f32 v52, -v52, v56
  v_cndmask_b32 v56, v52, v56, vcc
  s_mov_b32 exec_hi, 0
  global_store_dword v67, v56, s[16:17] sc1
  s_mov_b64 exec, -1
  s_branch K1_PUB
K1_NOTXT:
  s_cmp_ge_u32 s2, 224
  s_cbranch_scc1 K1_IDLE
  s_sub_u32 s6, s2, 128
  s_and_b32 s7, s6, 1
  s_lshr_b32 s6, s6, 1
  v_lshrrev_b32 v2, 3, v0
  v_mul_u32_u24 v4, 6144, v2
  v_and_b32 v5, 7, v0
  v_lshl_add_u32 v60, v5, 4, v4
  v_lshlrev_b32 v2, 1, v2
  s_mul_i32 s12, s7, 1572864
  s_lshl_b32 s13, s6, 7
  s_add_u32 s12, s12, s13
  s_lshl_b32 s13, s7, 9
  s_waitcnt lgkmcnt(0)
  s_barrier
  s_add_u32 s42, s42, s12
  s_addc_u32 s43, s43, 0
  s_add_u32 s40, s40, s13
  s_addc_u32 s41, s41, 0
  global_load_ushort v4, v2, s[40:41] offset:0
  global_load_ushort v5, v2, s[40:41] offset:64
  global_load_ushort v6, v2, s[40:41] offset:128
  global_load_ushort v7, v2, s[40:41] offset:192
  global_load_ushort v8, v2, s[40:41] offset:256
  global_load_ushort v9, v2, s[40:41] offset:320
  global_load_ushort v10, v2, s[40:41] offset:384
  global_load_ushort v11, v2, s[40:41] offset:448
  s_setprio 0
  s_mov_b32 s36, 2097152
K1_LQ:
  ds_read_b32 v113, v110 offset:28
  s_sub_u32 s36, s36, 1
  s_waitcnt lgkmcnt(0)
  v_readfirstlane_b32 s35, v113
  s_nop 1
  s_cmp_eq_u32 s35, 1
  s_cbranch_scc1 K1_XQ
  s_sleep 2
  s_cmp_lg_u32 s36, 0
  s_cbranch_scc1 K1_LQ
K1_XQ:
  global_load_dwordx4 v[64:67], v60, s[42:43]
  s_add_u32 s42, s42, 196608
  s_addc_u32 s43, s43, 0
  global_load_dwordx4 v[68:71], v60, s[42:43]
  s_add_u32 s42, s42, 196608
  s_addc_u32 s43, s43, 0
  global_load_dwordx4 v[72:75], v60, s[42:43]
  s_add_u32 s42, s42, 196608
  s_addc_u32 s43, s43, 0
  global_load_dwordx4 v[76:79], v60, s[42:43]
  s_add_u32 s42, s42, 196608
  s_addc_u32 s43, s43, 0
  global_load_dwordx4 v[80:83], v60, s[42:43]
  s_add_u32 s42, s42, 196608
  s_addc_u32 s43, s43, 0
  global_load_dwordx4 v[84:87], v60, s[42:43]
  s_add_u32 s42, s42, 196608
  s_addc_u32 s43, s43, 0
  global_load_dwordx4 v[88:91], v60, s[42:43]
  s_add_u32 s42, s42, 196608
  s_addc_u32 s43, s43, 0
  global_load_dwordx4 v[92:95], v60, s[42:43]
  v_lshlrev_b32 v2, 5, v0
  v_add_u32 v2, 77056, v2
  s_waitcnt vmcnt(8)
  v_lshlrev_b32 v4, 16, v4
  v_lshlrev_b32 v5, 16, v5
  v_lshlrev_b32 v6, 16, v6
  v_lshlrev_b32 v7, 16, v7
  v_lshlrev_b32 v8, 16, v8
  v_lshlrev_b32 v9, 16, v9
  v_lshlrev_b32 v10, 16, v10
  v_lshlrev_b32 v11, 16, v11
  v_mul_f32 v24, 0xbfb8aa3b, v4
  v_mul_f32 v25, 0xbfb8aa3b, v5
  v_mul_f32 v26, 0xbfb8aa3b, v6
  v_mul_f32 v27, 0xbfb8aa3b, v7
  v_mul_f32 v28, 0xbfb8aa3b, v8
  v_mul_f32 v29, 0xbfb8aa3b, v9
  v_mul_f32 v30, 0xbfb8aa3b, v10
  v_mul_f32 v31, 0xbfb8aa3b, v11
  v_exp_f32 v24, v24
  v_exp_f32 v25, v25
  v_exp_f32 v26, v26
  v_exp_f32 v27, v27
  v_exp_f32 v28, v28
  v_exp_f32 v29, v29
  v_exp_f32 v30, v30
  v_exp_f32 v31, v31
  v_pk_add_f32 v[24:25], v[24:25], 1.0 op_sel:[0,0] op_sel_hi:[1,0]
  v_pk_add_f32 v[26:27], v[26:27], 1.0 op_sel:[0,0] op_sel_hi:[1,0]
  v_pk_add_f32 v[28:29], v[28:29], 1.0 op_sel:[0,0] op_sel_hi:[1,0]
  v_pk_add_f32 v[30:31], v[30:31], 1.0 op_sel:[0,0] op_sel_hi:[1,0]
  v_rcp_f32 v24, v24
  v_rcp_f32 v25, v25
  v_rcp_f32 v26, v26
  v_rcp_f32 v27, v27
  v_rcp_f32 v28, v28
  v_rcp_f32 v29, v29
  v_rcp_f32 v30, v30
  v_rcp_f32 v31, v31
  v_pk_mul_f32 v[4:5], v[4:5], v[24:25] op_sel:[0,0] op_sel_hi:[1,1]
  v_pk_mul_f32 v[6:7], v[6:7], v[26:27] op_sel:[0,0] op_sel_hi:[1,1]
  v_pk_mul_f32 v[8:9], v[8:9], v[28:29] op_sel:[0,0] op_sel_hi:[1,1]
  v_pk_mul_f32 v[10:11], v[10:11], v[30:31] op_sel:[0,0] op_sel_hi:[1,1]
  v_cvt_pk_bf16_f32 v24, v4, v5
  v_lshlrev_b32 v4, 16, v24
  v_and_b32 v5, 0xffff0000, v24
  v_cvt_pk_bf16_f32 v24, v6, v7
  v_lshlrev_b32 v6, 16, v24
  v_and_b32 v7, 0xffff0000, v24
  v_cvt_pk_bf16_f32 v24, v8, v9
  v_lshlrev_b32 v8, 16, v24
  v_and_b32 v9, 0xffff0000, v24
  v_cvt_pk_bf16_f32 v24, v10, v11
  v_lshlrev_b32 v10, 16, v24
  v_and_b32 v11, 0xffff0000, v24
  s_waitcnt vmcnt(7)
  v_lshlrev_b32 v24, 16, v64
  v_and_b32 v25, 0xffff0000, v64
  v_lshlrev_b32 v26, 16, v65
  v_and_b32 v27, 0xffff0000, v65
  v_lshlrev_b32 v28, 16, v66
  v_and_b32 v29, 0xffff0000, v66
  v_lshlrev_b32 v30, 16, v67
  v_and_b32 v31, 0xffff0000, v67
  v_pk_mul_f32 v[32:33], v[24:25], v[4:5] op_sel:[0,0] op_sel_hi:[1,0]
  v_pk_mul_f32 v[34:35], v[26:27], v[4:5] op_sel:[0,0] op_sel_hi:[1,0]
  v_pk_mul_f32 v[36:37], v[28:29], v[4:5] op_sel:[0,0] op_sel_hi:[1,0]
  v_pk_mul_f32 v[38:39], v[30:31], v[4:5] op_sel:[0,0] op_sel_hi:[1,0]
  s_waitcnt vmcnt(6)
  v_lshlrev_b32 v24, 16, v68
  v_and_b32 v25, 0xffff0000, v68
  v_lshlrev_b32 v26, 16, v69
  v_and_b32 v27, 0xffff0000, v69
  v_lshlrev_b32 v28, 16, v70
  v_and_b32 v29, 0xffff0000, v70
  v_lshlrev_b32 v30, 16, v71
  v_and_b32 v31, 0xffff0000, v71
  v_pk_fma_f32 v[32:33], v[4:5], v[24:25], v[32:33] op_sel:[1,0,0] op_sel_hi:[1,1,1]
  v_pk_fma_f32 v[34:35], v[4:5], v[26:27], v[34:35] op_sel:[1,0,0] op_sel_hi:[1,1,1]
  v_pk_fma_f32 v[36:37], v[4:5], v[28:29], v[36:37] op_sel:[1,0,0] op_sel_hi:[1,1,1]
  v_pk_fma_f32 v[38:39], v[4:5], v[30:31], v[38:39] op_sel:[1,0,0] op_sel_hi:[1,1,1]
  s_waitcnt vmcnt(5)
  v_lshlrev_b32 v24, 16, v72
  v_and_b32 v25, 0xffff0000, v72
  v_lshlrev_b32 v26, 16, v73
  v_and_b32 v27, 0xffff0000, v73
  v_lshlrev_b32 v28, 16, v74
  v_and_b32 v29, 0xffff0000, v74
  v_lshlrev_b32 v30, 16, v75
  v_and_b32 v31, 0xffff0000, v75
  v_pk_fma_f32 v[32:33], v[24:25], v[6:7], v[32:33] op_sel:[0,0,0] op_sel_hi:[1,0,1]
  v_pk_fma_f32 v[34:35], v[26:27], v[6:7], v[34:35] op_sel:[0,0,0] op_sel_hi:[1,0,1]
  v_pk_fma_f32 v[36:37], v[28:29], v[6:7], v[36:37] op_sel:[0,0,0] op_sel_hi:[1,0,1]
  v_pk_fma_f32 v[38:39], v[30:31], v[6:7], v[38:39] op_sel:[0,0,0] op_sel_hi:[1,0,1]
  s_waitcnt vmcnt(4)
  v_lshlrev_b32 v24, 16, v76
  v_and_b32 v25, 0xffff0000, v76
  v_lshlrev_b32 v26, 16, v77
  v_and_b32 v27, 0xffff0000, v77
  v_lshlrev_b32 v28, 16, v78
  v_and_b32 v29, 0xffff0000, v78
  v_lshlrev_b32 v30, 16, v79
  v_and_b32 v31, 0xffff0000, v79
  v_pk_fma_f32 v[32:33], v[6:7], v[24:25], v[32:33] op_sel:[1,0,0] op_sel_hi:[1,1,1]
  v_pk_fma_f32 v[34:35], v[6:7], v[26:27], v[34:35] op_sel:[1,0,0] op_sel_hi:[1,1,1]
  v_pk_fma_f32 v[36:37], v[6:7], v[28:29], v[36:37] op_sel:[1,0,0] op_sel_hi:[1,1,1]
  v_pk_fma_f32 v[38:39], v[6:7], v[30:31], v[38:39] op_sel:[1,0,0] op_sel_hi:[1,1,1]
  s_waitcnt vmcnt(3)
  v_lshlrev_b32 v24, 16, v80
  v_and_b32 v25, 0xffff0000, v80
  v_lshlrev_b32 v26, 16, v81
  v_and_b32 v27, 0xffff0000, v81
  v_lshlrev_b32 v28, 16, v82
  v_and_b32 v29, 0xffff0000, v82
  v_lshlrev_b32 v30, 16, v83
  v_and_b32 v31, 0xffff0000, v83
  v_pk_fma_f32 v[32:33], v[24:25], v[8:9], v[32:33] op_sel:[0,0,0] op_sel_hi:[1,0,1]
  v_pk_fma_f32 v[34:35], v[26:27], v[8:9], v[34:35] op_sel:[0,0,0] op_sel_hi:[1,0,1]
  v_pk_fma_f32 v[36:37], v[28:29], v[8:9], v[36:37] op_sel:[0,0,0] op_sel_hi:[1,0,1]
  v_pk_fma_f32 v[38:39], v[30:31], v[8:9], v[38:39] op_sel:[0,0,0] op_sel_hi:[1,0,1]
  s_waitcnt vmcnt(2)
  v_lshlrev_b32 v24, 16, v84
  v_and_b32 v25, 0xffff0000, v84
  v_lshlrev_b32 v26, 16, v85
  v_and_b32 v27, 0xffff0000, v85
  v_lshlrev_b32 v28, 16, v86
  v_and_b32 v29, 0xffff0000, v86
  v_lshlrev_b32 v30, 16, v87
  v_and_b32 v31, 0xffff0000, v87
  v_pk_fma_f32 v[32:33], v[8:9], v[24:25], v[32:33] op_sel:[1,0,0] op_sel_hi:[1,1,1]
  v_pk_fma_f32 v[34:35], v[8:9], v[26:27], v[34:35] op_sel:[1,0,0] op_sel_hi:[1,1,1]
  v_pk_fma_f32 v[36:37], v[8:9], v[28:29], v[36:37] op_sel:[1,0,0] op_sel_hi:[1,1,1]
  v_pk_fma_f32 v[38:39], v[8:9], v[30:31], v[38:39] op_sel:[1,0,0] op_sel_hi:[1,1,1]
  s_waitcnt vmcnt(1)
  v_lshlrev_b32 v24, 16, v88
  v_and_b32 v25, 0xffff0000, v88
  v_lshlrev_b32 v26, 16, v89
  v_and_b32 v27, 0xffff0000, v89
  v_lshlrev_b32 v28, 16, v90
  v_and_b32 v29, 0xffff0000, v90
  v_lshlrev_b32 v30, 16, v91
  v_and_b32 v31, 0xffff0000, v91
  v_pk_fma_f32 v[32:33], v[24:25], v[10:11], v[32:33] op_sel:[0,0,0] op_sel_hi:[1,0,1]
  v_pk_fma_f32 v[34:35], v[26:27], v[10:11], v[34:35] op_sel:[0,0,0] op_sel_hi:[1,0,1]
  v_pk_fma_f32 v[36:37], v[28:29], v[10:11], v[36:37] op_sel:[0,0,0] op_sel_hi:[1,0,1]
  v_pk_fma_f32 v[38:39], v[30:31], v[10:11], v[38:39] op_sel:[0,0,0] op_sel_hi:[1,0,1]
  s_waitcnt vmcnt(0)
  v_lshlrev_b32 v24, 16, v92
  v_and_b32 v25, 0xffff0000, v92
  v_lshlrev_b32 v26, 16, v93
  v_and_b32 v27, 0xffff0000, v93
  v_lshlrev_b32 v28, 16, v94
  v_and_b32 v29, 0xffff0000, v94
  v_lshlrev_b32 v30, 16, v95
  v_and_b32 v31, 0xffff0000, v95
  v_pk_fma_f32 v[32:33], v[10:11], v[24:25], v[32:33] op_sel:[1,0,0] op_sel_hi:[1,1,1]
  v_pk_fma_f32 v[34:35], v[10:11], v[26:27], v[34:35] op_sel:[1,0,0] op_sel_hi:[1,1,1]
  v_pk_fma_f32 v[36:37], v[10:11], v[28:29], v[36:37] op_sel:[1,0,0] op_sel_hi:[1,1,1]
  v_pk_fma_f32 v[38:39], v[10:11], v[30:31], v[38:39] op_sel:[1,0,0] op_sel_hi:[1,1,1]
  ds_write_b128 v2, v[32:35]
  ds_write_b128 v2, v[36:39] offset:16
  v_mov_b32 v113, 1
  s_cmp_lg_u32 s33, 4
  s_waitcnt lgkmcnt(0)
  s_cbranch_scc0 K1_M4
  s_mov_b64 exec, 1
  ds_add_u32 v110, v113 offset:24
  s_mov_b64 exec, -1
  s_mov_b32 s36, 131072
K1_MW:
  ds_read_b32 v113, v110 offset:4
  s_sub_u32 s36, s36, 1
  s_waitcnt lgkmcnt(0)
  v_readfirstlane_b32 s35, v113
  s_nop 1
  s_cmp_lg_u32 s35, 0
  s_cbranch_scc1 K1_PUB
  s_sleep 1
  s_cmp_lg_u32 s36, 0
  s_cbranch_scc1 K1_MW
  s_branch K1_PUB
K1_M4:
  s_mov_b32 s36, 2097152
K1_LR:
  ds_read_b32 v113, v110 offset:24
  s_sub_u32 s36, s36, 1
  s_waitcnt lgkmcnt(0)
  v_readfirstlane_b32 s35, v113
  s_nop 1
  s_cmp_eq_u32 s35, 3
  s_cbranch_scc1 K1_XR
  s_cmp_lg_u32 s36, 0
  s_cbranch_scc1 K1_LR
K1_XR:
  v_lshlrev_b32 v2, 2, v0
  v_add_u32 v2, 77056, v2
  ds_read2st64_b32 v[4:5], v2 offset0:0 offset1:1
  ds_read2st64_b32 v[6:7], v2 offset0:2 offset1:3
  ds_read2st64_b32 v[8:9], v2 offset0:4 offset1:5
  ds_read2st64_b32 v[10:11], v2 offset0:6 offset1:7
  ds_read2st64_b32 v[12:13], v2 offset0:8 offset1:9
  ds_read2st64_b32 v[14:15], v2 offset0:10 offset1:11
  ds_read2st64_b32 v[16:17], v2 offset0:12 offset1:13
  ds_read2st64_b32 v[18:19], v2 offset0:14 offset1:15
  ds_read2st64_b32 v[20:21], v2 offset0:16 offset1:17
  ds_read2st64_b32 v[22:23], v2 offset0:18 offset1:19
  ds_read2st64_b32 v[24:25], v2 offset0:20 offset1:21
  ds_read2st64_b32 v[26:27], v2 offset0:22 offset1:23
  ds_read2st64_b32 v[28:29], v2 offset0:24 offset1:25
  ds_read2st64_b32 v[30:31], v2 offset0:26 offset1:27
  ds_read2st64_b32 v[32:33], v2 offset0:28 offset1:29
  ds_read2st64_b32 v[34:35], v2 offset0:30 offset1:31
  s_lshl_b32 s6, s6, 8
  s_mul_i32 s7, s7, 12288
  s_add_u32 s6, s6, s7
  v_lshl_add_u32 v2, v0, 2, s6
  s_waitcnt lgkmcnt(0)
  v_pk_add_f32 v[4:5], v[4:5], v[20:21] op_sel:[0,0] op_sel_hi:[1,1]
  v_pk_add_f32 v[6:7], v[6:7], v[22:23] op_sel:[0,0] op_sel_hi:[1,1]
  v_pk_add_f32 v[8:9], v[8:9], v[24:25] op_sel:[0,0] op_sel_hi:[1,1]
  v_pk_add_f32 v[10:11], v[10:11], v[26:27] op_sel:[0,0] op_sel_hi:[1,1]
  v_pk_add_f32 v[12:13], v[12:13], v[28:29] op_sel:[0,0] op_sel_hi:[1,1]
  v_pk_add_f32 v[14:15], v[14:15], v[30:31] op_sel:[0,0] op_sel_hi:[1,1]
  v_pk_add_f32 v[16:17], v[16:17], v[32:33] op_sel:[0,0] op_sel_hi:[1,1]
  v_pk_add_f32 v[18:19], v[18:19], v[34:35] op_sel:[0,0] op_sel_hi:[1,1]
  v_pk_add_f32 v[4:5], v[4:5], v[12:13] op_sel:[0,0] op_sel_hi:[1,1]
  v_pk_add_f32 v[6:7], v[6:7], v[14:15] op_sel:[0,0] op_sel_hi:[1,1]
  v_pk_add_f32 v[8:9], v[8:9], v[16:17] op_sel:[0,0] op_sel_hi:[1,1]
  v_pk_add_f32 v[10:11], v[10:11], v[18:19] op_sel:[0,0] op_sel_hi:[1,1]
  v_pk_add_f32 v[4:5], v[4:5], v[8:9] op_sel:[0,0] op_sel_hi:[1,1]
  v_pk_add_f32 v[6:7], v[6:7], v[10:11] op_sel:[0,0] op_sel_hi:[1,1]
  v_pk_add_f32 v[4:5], v[4:5], v[6:7] op_sel:[0,0] op_sel_hi:[1,1]
  v_add_f32 v4, v4, v5
  global_store_dword v2, v4, s[4:5] sc1
  global_load_dword v115, v111, s[50:51] sc1
  ds_write_b32 v110, v110 offset:4
  s_branch K1_PUB2
K1_IDLE:
  s_getpc_b64 s[22:23]
PF_a:
  s_sub_u32 s22, s22, PF_a-prep_kernel
  s_subb_u32 s23, s23, 0
  v_lshlrev_b32 v150, 7, v0
  v_min_u32 v150, CODE_END-prep_kernel-4, v150
  global_load_dword v150, v150, s[22:23]
  s_waitcnt lgkmcnt(0)
  s_barrier
K1_PUB:
  global_load_dword v115, v111, s[50:51] sc1
K1_PUB2:
K1_NOW:
  v_mov_b32 v112, 1
  s_lshr_b32 s34, s2, 2
  s_lshl_b32 s34, s34, 7
  s_and_b32 s35, s2, 3
  s_lshl_b32 s35, s35, 2
  s_add_u32 s34, s34, s35
  v_mov_b32 v113, s34
  s_add_u32 s22, s4, 0x5a000
  s_addc_u32 s23, s5, 0
  s_waitcnt vmcnt(0)
  s_mov_b64 exec, 1
  ds_add_rtn_u32 v114, v110, v112
  s_mov_b32 s36, 131072
  s_waitcnt lgkmcnt(0)
  v_readfirstlane_b32 s35, v114
  s_nop 1
  s_cmp_lg_u32 s35, 3
  s_cbranch_scc1 K1_NL
K1_T0:
  v_readfirstlane_b32 s35, v115
  s_nop 1
  s_cmp_lg_u32 s35, 0
  s_cbranch_scc1 K1_T1
  global_load_dword v115, v111, s[50:51] sc1
  s_sub_u32 s36, s36, 1
  s_cmp_lg_u32 s36, 0
  s_waitcnt vmcnt(0)
  s_cbranch_scc1 K1_T0
K1_T1:
  global_store_dword v113, v115, s[22:23] sc1
K1_NL:
  s_mov_b64 exec, -1
  s_and_b32 s6, s2, 7
  s_lshl_b32 s6, s6, 5
  s_lshr_b32 s7, s2, 3
  s_add_u32 s6, s6, s7
  s_lshl_b32 s6, s6, 1
  v_and_b32 v42, 1, v1
  v_add_u32 v40, s6, v42
  v_lshlrev_b32 v41, 1, v40
  v_lshlrev_b32 v40, 2, v40
  s_setprio 0
  s_and_b32 s12, s2, 3
  s_bfe_u32 s13, s2, 0x10002
  s_lshr_b32 s14, s2, 3
  v_bfe_u32 v52, v0, 2, 1
  v_and_b32 v53, 3, v0
  v_lshl_add_u32 v52, v52, 3, v53
  v_lshl_add_u32 v2, v3, 5, v52
  v_mul_u32_u24 v2, 3584, v2
  v_lshrrev_b32 v54, 4, v1
  v_lshl_add_u32 v2, v54, 4, v2
  v_bfe_u32 v52, v0, 3, 1
  v_lshl_add_u32 v2, v52, 6, v2
  s_mul_i32 s15, s12, 458752
  s_lshl_b32 s16, s14, 7
  s_add_u32 s15, s15, s16
  s_cmp_eq_u32 s13, 0
  s_cselect_b32 s8, s44, s46
  s_cselect_b32 s9, s45, s47
  s_add_u32 s8, s8, s15
  s_addc_u32 s9, s9, 0
  s_sub_u32 s30, s33, 4
  s_lshl_b32 s28, s2, 13
  s_add_u32 s24, s48, s28
  s_addc_u32 s25, s49, 0
  s_mov_b32 s26, 8192
  s_mov_b32 s27, 0x20000
  v_lshrrev_b32 v58, 3, v1
  v_lshlrev_b32 v58, 10, v58
  v_and_b32 v59, 7, v1
  v_lshl_add_u32 v58, v59, 4, v58
  s_lshl_b32 s29, s30, 8
  s_lshl_b32 s28, s30, 11
  s_add_u32 s28, s28, 97536
  v_and_b32 v60, 1, v1
  v_lshlrev_b32 v60, 4, v60
  v_mov_b32 v61, 0x3f80
  v_lshlrev_b32 v60, v60, v61
  v_bfe_u32 v61, v1, 1, 3
  v_lshlrev_b32 v62, 2, v54
  v_sub_u32 v61, v62, v61
  v_cmp_eq_u32 vcc, 0, v61
  s_nop 1
  v_cndmask_b32 v32, 0, v60, vcc
  v_cmp_eq_u32 vcc, -1, v61
  s_nop 1
  v_cndmask_b32 v33, 0, v60, vcc
  v_cmp_eq_u32 vcc, -2, v61
  s_nop 1
  v_cndmask_b32 v34, 0, v60, vcc
  v_cmp_eq_u32 vcc, -3, v61
  s_nop 1
  v_cndmask_b32 v35, 0, v60, vcc
  v_cmp_eq_u32 vcc, 8, v61
  s_nop 1
  v_cndmask_b32 v36, 0, v60, vcc
  v_cmp_eq_u32 vcc, 7, v61
  s_nop 1
  v_cndmask_b32 v37, 0, v60, vcc
  v_cmp_eq_u32 vcc, 6, v61
  s_nop 1
  v_cndmask_b32 v38, 0, v60, vcc
  v_cmp_eq_u32 vcc, 5, v61
  s_nop 1
  v_cndmask_b32 v39, 0, v60, vcc
  v_mov_b32 v48, 0x3f803f80
  v_mov_b32 v49, 0x3f803f80
  v_mov_b32 v50, 0x3f803f80
  v_mov_b32 v51, 0x3f803f80
  v_lshlrev_b32 v45, 2, v0
  v_add_u32 v45, 93440, v45
  v_lshlrev_b32 v63, 8, v3
  v_lshl_add_u32 v63, v54, 5, v63
  v_add_u32 v63, 93440, v63
  v_lshlrev_b32 v44, 11, v3
  v_lshl_add_u32 v44, v1, 4, v44
  s_lshl_b32 s15, s14, 17
  s_lshl_b32 s16, s12, 13
  s_add_u32 s15, s15, s16
  s_lshl_b32 s16, s13, 10
  s_add_u32 s15, s15, s16
  s_add_u32 s15, s15, 0xc00000
  s_add_u32 s56, s4, s15
  s_addc_u32 s57, s5, 0
  v_bfe_u32 v47, v1, 2, 2
  v_lshlrev_b32 v46, 5, v54
  v_lshl_add_u32 v46, v47, 7, v46
  v_lshl_add_u32 v46, v53, 3, v46
  v_add_u32 v46, s28, v46
  v_lshrrev_b32 v47, 5, v1
  v_mul_u32_u24 v47, 114688, v47
  v_and_b32 v60, 31, v1
  v_lshl_add_u32 v47, v60, 4, v47
  s_mul_i32 s38, s30, 458752
  s_lshl_b32 s39, s2, 9
  s_add_u32 s38, s38, s39
  s_add_u32 s38, s38, 0x1000000
  s_add_u32 s40, s4, s38
  s_addc_u32 s41, s5, 0
  s_add_u32 s42, s40, 229376
  s_addc_u32 s43, s41, 0
  s_mov_b32 s36, 2097152
K1_LB:
  ds_read_b32 v113, v110 offset:44
  s_sub_u32 s36, s36, 1
  s_waitcnt lgkmcnt(0)
  v_readfirstlane_b32 s35, v113
  s_nop 1
  s_cmp_eq_u32 s35, 4
  s_cbranch_scc1 K1_XB
  s_sleep 2
  s_cmp_lg_u32 s36, 0
  s_cbranch_scc1 K1_LB
K1_XB:
  s_cmp_ge_u32 s2, 224
  s_cbranch_scc1 K1_NOW2
  global_load_dwordx4 v[120:123], v2, s[8:9]
  s_add_u32 s8, s8, 14336
  s_addc_u32 s9, s9, 0
  global_load_dwordx4 v[124:127], v2, s[8:9]
  s_add_u32 s8, s8, 43008
  s_addc_u32 s9, s9, 0
  global_load_dwordx4 v[128:131], v2, s[8:9]
  s_add_u32 s8, s8, 14336
  s_addc_u32 s9, s9, 0
  global_load_dwordx4 v[132:135], v2, s[8:9]
  s_mov_b32 m0, s28
  s_nop 0
  buffer_load_dwordx4 v58, s[24:27], s29 offen lds
  s_add_u32 m0, s28, 1024
  s_add_u32 s29, s29, 128
  buffer_load_dwordx4 v58, s[24:27], s29 offen lds
K1_NOW2:
  s_setprio 3
  s_cmp_lg_u32 s33, 7
  s_cbranch_scc1 K1_N7
  v_min_u32 v113, 23, v1
  v_lshlrev_b32 v113, 7, v113
  v_add_u32 v113, 4096, v113
  global_load_ushort v43, v41, s[54:55]
  s_add_u32 s18, s4, 2048
  s_addc_u32 s19, s5, 0
  s_add_u32 s20, s18, 12288
  s_addc_u32 s21, s19, 0
  s_mov_b32 s36, 131072
  s_mov_b64 exec, 0xffffff
K1_G2:
  global_load_dword v115, v111, s[50:51] sc1
  global_load_dwordx4 v[116:119], v113, s[22:23] sc1
  s_waitcnt vmcnt(0)
  v_xor_b32 v116, v116, v115
  v_xor_b32 v117, v117, v115
  v_xor_b32 v118, v118, v115
  v_xor_b32 v119, v119, v115
  v_or3_b32 v116, v116, v117, v118
  v_and_b32 v117, 1, v115
  v_xor_b32 v117, 1, v117
  v_or3_b32 v116, v116, v119, v117
  v_cmp_ne_u32 vcc, 0, v116
  s_nop 1
  s_cmp_eq_u64 vcc, 0
  s_cbranch_scc1 K1_G2X
  s_mov_b64 exec, vcc
  s_sleep 4
  s_sub_u32 s36, s36, 1
  s_cmp_lg_u32 s36, 0
  s_cbranch_scc1 K1_G2
K1_G2X:
  s_mov_b64 exec, -1
  ds_write_b32 v110, v112 offset:16
  global_load_dword v24, v40, s[18:19] offset:-2048 sc1
  global_load_dword v25, v40, s[18:19] offset:0 sc1
  global_load_dword v26, v40, s[18:19] offset:2048 sc1
  global_load_dword v28, v40, s[20:21] offset:-2048 sc1
  global_load_dword v29, v40, s[20:21] offset:0 sc1
  global_load_dword v30, v40, s[20:21] offset:2048 sc1
  s_branch K1_N7X
K1_N7:
  s_cmp_lg_u32 s33, 6
  s_cbranch_scc1 K1_N6
  s_lshl_b32 s20, s2, 7
  v_lshrrev_b32 v31, 5, v1
  v_and_b32 v28, 31, v1
  v_lshlrev_b32 v29, 2, v28
  v_mul_u32_u24 v30, 32768, v31
  v_add3_u32 v29, v29, v30, s20
  v_and_b32 v28, 33, v1
  v_cmp_eq_u32 vcc, 1, v28
  v_mov_b32 v31, 0xbf800000
  s_add_u32 s20, s4, 0x40000
  s_addc_u32 s21, s5, 0
  v_cndmask_b32 v28, 0, v31, vcc
  global_store_dword v29, v28, s[20:21] sc1
K1_N6:
  s_mov_b32 s46, 2097152
K1_LG:
  ds_read_b32 v113, v110 offset:16
  s_sub_u32 s46, s46, 1
  s_waitcnt lgkmcnt(0)
  v_readfirstlane_b32 s45, v113
  s_nop 1
  s_cmp_eq_u32 s45, 1
  s_cbranch_scc1 K1_XG
  s_sleep 2
  s_cmp_lg_u32 s46, 0
  s_cbranch_scc1 K1_LG
K1_XG:
K1_N7X:
  s_cmp_ge_u32 s2, 224
  s_cbranch_scc1 K1_NF0
  s_lshl_b32 s16, s12, 9
  s_lshl_b32 s17, s30, 7
  s_add_u32 s16, s16, s17
  s_add_u32 s16, s16, 6144
  v_and_b32 v55, 31, v1
  v_lshlrev_b32 v56, 2, v55
  v_lshrrev_b32 v57, 5, v1
  v_lshl_add_u32 v56, v57, 11, v56
  s_add_u32 s18, s4, s16
  s_addc_u32 s19, s5, 0
  global_load_dword v20, v56, s[18:19] sc1
  s_add_u32 s18, s18, 12288
  s_addc_u32 s19, s19, 0
  global_load_dword v21, v56, s[18:19] sc1
K1_NF0:
  s_cmp_lg_u32 s33, 7
  s_cbranch_scc1 K1_NC
  v_lshlrev_b32 v42, 4, v42
  s_waitcnt vmcnt(0)
  v_pk_add_f32 v[24:25], v[24:25], v[28:29] op_sel:[0,0] op_sel_hi:[1,1]
  v_pk_add_f32 v[26:27], v[26:27], v[30:31] op_sel:[0,0] op_sel_hi:[1,1]
  v_cvt_pk_bf16_f32 v28, v24, v25
  v_lshlrev_b32 v24, 16, v28
  v_and_b32 v25, 0xffff0000, v28
  v_cvt_pk_bf16_f32 v29, v26, v27
  v_lshlrev_b32 v26, 16, v29
  v_and_b32 v27, 0xffff0000, v29
  v_add_f32 v25, 1.0, v25
  v_cvt_pk_bf16_f32 v25, v25, v25
  v_lshlrev_b32 v25, 16, v25
  v_lshlrev_b32 v43, 16, v43
  v_mul_f32 v28, v26, v25
  v_mul_f32 v30, v26, v24
  v_mul_f32 v29, v28, v43
  v_mul_f32 v31, v30, v43
  v_add_u32 v42, 105792, v42
  ds_write_b128 v42, v[28:31]
  ds_write_b32 v110, v112 offset:12
K1_NC:
  s_cmp_lt_u32 s2, 224
  s_cbranch_scc1 K1_FOLD
  s_branch K1_FIN
K1_FOLD:
  s_setprio 3
  v_cvt_f32_u32 v57, v57
  s_waitcnt vmcnt(0)
  v_add_f32 v20, v20, v21
  v_cvt_pk_bf16_f32 v20, v20, v20
  v_lshlrev_b32 v20, 16, v20
  v_add_f32 v20, v20, v57
  v_cvt_pk_bf16_f32 v20, v20, v20
  v_lshlrev_b32 v20, 16, v20
  ds_write_b32 v45, v20
  ds_read_b128 v[64:67], v63
  ds_read_b128 v[68:71], v63 offset:16
  ds_read_b128 v[72:75], v63 offset:128
  ds_read_b128 v[76:79], v63 offset:144
  s_waitcnt vmcnt(0)
  ds_read_b64_tr_b16 v[24:25], v46 offset:0
  ds_read_b64_tr_b16 v[26:27], v46 offset:512
  ds_read_b64_tr_b16 v[28:29], v46 offset:1024
  ds_read_b64_tr_b16 v[30:31], v46 offset:1536
  v_mfma_f32_16x16x32_bf16 v[80:83], v[120:123], v[32:35], 0
  v_mfma_f32_16x16x32_bf16 v[84:87], v[124:127], v[32:35], 0
  v_mfma_f32_16x16x32_bf16 v[88:91], v[120:123], v[36:39], 0
  v_mfma_f32_16x16x32_bf16 v[92:95], v[124:127], v[36:39], 0
  v_mfma_f32_16x16x32_bf16 v[96:99], v[128:131], v[32:35], 0
  v_mfma_f32_16x16x32_bf16 v[100:103], v[132:135], v[32:35], 0
  v_mfma_f32_16x16x32_bf16 v[104:107], v[128:131], v[36:39], 0
  v_mfma_f32_16x16x32_bf16 v[108:111], v[132:135], v[36:39], 0
  s_waitcnt lgkmcnt(0)
  global_store_dwordx4 v47, v[24:27], s[40:41] sc1
  global_store_dwordx4 v47, v[28:31], s[42:43] sc1
  s_nop 1
  v_permlane32_swap_b32 v80, v96
  v_permlane32_swap_b32 v81, v97
  v_permlane32_swap_b32 v82, v98
  v_permlane32_swap_b32 v83, v99
  v_permlane32_swap_b32 v84, v100
  v_permlane32_swap_b32 v85, v101
  v_permlane32_swap_b32 v86, v102
  v_permlane32_swap_b32 v87, v103
  v_permlane32_swap_b32 v88, v104
  v_permlane32_swap_b32 v89, v105
  v_permlane32_swap_b32 v90, v106
  v_permlane32_swap_b32 v91, v107
  v_permlane32_swap_b32 v92, v108
  v_permlane32_swap_b32 v93, v109
  v_permlane32_swap_b32 v94, v110
  v_permlane32_swap_b32 v95, v111
  v_pk_mul_f32 v[128:129], v[80:81], v[64:65] op_sel:[0,0] op_sel_hi:[1,1]
  v_pk_fma_f32 v[128:129], v[82:83], v[66:67], v[128:129] op_sel:[0,0,0] op_sel_hi:[1,1,1]
  v_pk_fma_f32 v[128:129], v[84:85], v[68:69], v[128:129] op_sel:[0,0,0] op_sel_hi:[1,1,1]
  v_pk_fma_f32 v[128:129], v[86:87], v[70:71], v[128:129] op_sel:[0,0,0] op_sel_hi:[1,1,1]
  v_pk_mul_f32 v[80:81], v[80:81], v[72:73] op_sel:[0,0] op_sel_hi:[1,1]
  v_pk_mul_f32 v[82:83], v[82:83], v[74:75] op_sel:[0,0] op_sel_hi:[1,1]
  v_pk_mul_f32 v[84:85], v[84:85], v[76:77] op_sel:[0,0] op_sel_hi:[1,1]
  v_pk_mul_f32 v[86:87], v[86:87], v[78:79] op_sel:[0,0] op_sel_hi:[1,1]
  v_cvt_pk_bf16_f32 v4, v80, v81
  v_cvt_pk_bf16_f32 v5, v82, v83
  v_cvt_pk_bf16_f32 v6, v84, v85
  v_cvt_pk_bf16_f32 v7, v86, v87
  global_store_dwordx4 v44, v[4:7], s[56:57] sc1
  s_add_u32 s56, s56, 32768
  s_addc_u32 s57, s57, 0
  v_mfma_f32_16x16x32_bf16 v[136:139], v[48:51], v[4:7], 0
  v_pk_mul_f32 v[130:131], v[88:89], v[64:65] op_sel:[0,0] op_sel_hi:[1,1]
  v_pk_fma_f32 v[130:131], v[90:91], v[66:67], v[130:131] op_sel:[0,0,0] op_sel_hi:[1,1,1]
  v_pk_fma_f32 v[130:131], v[92:93], v[68:69], v[130:131] op_sel:[0,0,0] op_sel_hi:[1,1,1]
  v_pk_fma_f32 v[130:131], v[94:95], v[70:71], v[130:131] op_sel:[0,0,0] op_sel_hi:[1,1,1]
  v_pk_mul_f32 v[88:89], v[88:89], v[72:73] op_sel:[0,0] op_sel_hi:[1,1]
  v_pk_mul_f32 v[90:91], v[90:91], v[74:75] op_sel:[0,0] op_sel_hi:[1,1]
  v_pk_mul_f32 v[92:93], v[92:93], v[76:77] op_sel:[0,0] op_sel_hi:[1,1]
  v_pk_mul_f32 v[94:95], v[94:95], v[78:79] op_sel:[0,0] op_sel_hi:[1,1]
  v_cvt_pk_bf16_f32 v8, v88, v89
  v_cvt_pk_bf16_f32 v9, v90, v91
  v_cvt_pk_bf16_f32 v10, v92, v93
  v_cvt_pk_bf16_f32 v11, v94, v95
  global_store_dwordx4 v44, v[8:11], s[56:57] sc1
  s_add_u32 s56, s56, 32768
  s_addc_u32 s57, s57, 0
  v_mfma_f32_16x16x32_bf16 v[140:143], v[48:51], v[8:11], 0
  v_pk_mul_f32 v[132:133], v[96:97], v[64:65] op_sel:[0,0] op_sel_hi:[1,1]
  v_pk_fma_f32 v[132:133], v[98:99], v[66:67], v[132:133] op_sel:[0,0,0] op_sel_hi:[1,1,1]
  v_pk_fma_f32 v[132:133], v[100:101], v[68:69], v[132:133] op_sel:[0,0,0] op_sel_hi:[1,1,1]
  v_pk_fma_f32 v[132:133], v[102:103], v[70:71], v[132:133] op_sel:[0,0,0] op_sel_hi:[1,1,1]
  v_pk_mul_f32 v[96:97], v[96:97], v[72:73] op_sel:[0,0] op_sel_hi:[1,1]
  v_pk_mul_f32 v[98:99], v[98:99], v[74:75] op_sel:[0,0] op_sel_hi:[1,1]
  v_pk_mul_f32 v[100:101], v[100:101], v[76:77] op_sel:[0,0] op_sel_hi:[1,1]
  v_pk_mul_f32 v[102:103], v[102:103], v[78:79] op_sel:[0,0] op_sel_hi:[1,1]
  v_cvt_pk_bf16_f32 v12, v96, v97
  v_cvt_pk_bf16_f32 v13, v98, v99
  v_cvt_pk_bf16_f32 v14, v100, v101
  v_cvt_pk_bf16_f32 v15, v102, v103
  global_store_dwordx4 v44, v[12:15], s[56:57] sc1
  s_add_u32 s56, s56, 32768
  s_addc_u32 s57, s57, 0
  v_mfma_f32_16x16x32_bf16 v[144:147], v[48:51], v[12:15], 0
  v_pk_mul_f32 v[134:135], v[104:105], v[64:65] op_sel:[0,0] op_sel_hi:[1,1]
  v_pk_fma_f32 v[134:135], v[106:107], v[66:67], v[134:135] op_sel:[0,0,0] op_sel_hi:[1,1,1]
  v_pk_fma_f32 v[134:135], v[108:109], v[68:69], v[134:135] op_sel:[0,0,0] op_sel_hi:[1,1,1]
  v_pk_fma_f32 v[134:135], v[110:111], v[70:71], v[134:135] op_sel:[0,0,0] op_sel_hi:[1,1,1]
  v_pk_mul_f32 v[104:105], v[104:105], v[72:73] op_sel:[0,0] op_sel_hi:[1,1]
  v_pk_mul_f32 v[106:107], v[106:107], v[74:75] op_sel:[0,0] op_sel_hi:[1,1]
  v_pk_mul_f32 v[108:109], v[108:109], v[76:77] op_sel:[0,0] op_sel_hi:[1,1]
  v_pk_mul_f32 v[110:111], v[110:111], v[78:79] op_sel:[0,0] op_sel_hi:[1,1]
  v_cvt_pk_bf16_f32 v16, v104, v105
  v_cvt_pk_bf16_f32 v17, v106, v107
  v_cvt_pk_bf16_f32 v18, v108, v109
  v_cvt_pk_bf16_f32 v19, v110, v111
  global_store_dwordx4 v44, v[16:19], s[56:57] sc1
  s_nop 0
  v_mfma_f32_16x16x32_bf16 v[148:151], v[48:51], v[16:19], 0
  v_add_f32 v128, v128, v129
  v_add_f32 v129, v130, v131
  v_add_f32 v130, v132, v133
  v_add_f32 v131, v134, v135
  v_permlane32_swap_b32 v128, v129
  s_nop 0
  v_permlane32_swap_b32 v130, v131
  v_cmp_eq_u32 s[26:27], 1, v54
  v_cmp_eq_u32 s[28:29], 2, v54
  v_cmp_eq_u32 s[30:31], 3, v54
  v_add_f32 v128, v128, v129
  v_add_f32 v130, v130, v131
  v_cndmask_b32 v136, v136, v144, s[26:27]
  s_nop 0
  v_permlane16_swap_b32 v128, v130
  v_cndmask_b32 v136, v136, v140, s[28:29]
  v_add_f32 v137, v128, v130
  v_cndmask_b32 v136, v136, v148, s[30:31]
  v_lshlrev_b32 v56, 3, v0
  v_add_u32 v56, 93440, v56
  ds_write_b64 v56, v[136:137] offset:1024
  v_mov_b32 v110, 105728
  s_waitcnt lgkmcnt(0)
  s_mov_b64 exec, 1
  ds_add_rtn_u32 v114, v110, v112 offset:40
  s_mov_b64 exec, -1
  s_waitcnt lgkmcnt(0)
  v_readfirstlane_b32 s22, v114
  s_nop 1
  s_cmp_lg_u32 s22, 3
  s_cbranch_scc1 K1_FIN
  v_lshlrev_b32 v56, 3, v1
  v_add_u32 v56, 93440, v56
  ds_read_b64 v[64:65], v56 offset:1024
  ds_read_b64 v[66:67], v56 offset:1536
  ds_read_b64 v[68:69], v56 offset:2048
  ds_read_b64 v[70:71], v56 offset:2560
  v_and_b32 v2, 1, v54
  v_lshlrev_b32 v2, 1, v2
  v_lshrrev_b32 v3, 1, v54
  v_add_u32 v2, v2, v3
  v_lshlrev_b32 v2, 4, v2
  v_and_b32 v3, 15, v1
  v_add_lshl_u32 v2, v2, v3, 2
  s_lshl_b32 s15, s2, 9
  s_add_u32 s15, s15, 0x11000
  s_add_u32 s20, s4, s15
  s_addc_u32 s21, s5, 0
  s_waitcnt lgkmcnt(0)
  v_pk_add_f32 v[64:65], v[64:65], v[66:67] op_sel:[0,0] op_sel_hi:[1,1]
  v_pk_add_f32 v[68:69], v[68:69], v[70:71] op_sel:[0,0] op_sel_hi:[1,1]
  v_pk_add_f32 v[64:65], v[64:65], v[68:69] op_sel:[0,0] op_sel_hi:[1,1]
  global_store_dword v2, v64, s[20:21] sc1
  global_store_dword v2, v65, s[20:21] offset:256 sc1
K1_FIN:
K1_END:
  s_endpgm
.globl gemm1_kernel
.p2align 8
.type gemm1_kernel,@function
gemm1_kernel:
  s_cmp_ge_u32 s2, 256
  s_cbranch_scc1 K2_END
  s_load_dwordx2 s[4:5], s[0:1], 136
  s_load_dwordx2 s[50:51], s[0:1], 120
  v_lshrrev_b32 v2, 6, v0
  v_and_b32 v1, 63, v0
  v_readfirstlane_b32 s33, v2
  s_and_b32 s6, s2, 7
  s_lshr_b32 s7, s2, 3
  s_lshr_b32 s8, s6, 1
  s_lshl_b32 s8, s8, 2
  s_lshr_b32 s9, s7, 3
  s_add_u32 s8, s8, s9
  s_and_b32 s30, s6, 1
  s_lshl_b32 s30, s30, 3
  s_and_b32 s10, s7, 7
  s_add_u32 s30, s30, s10
  s_mul_i32 s9, s30, 7
  v_lshlrev_b32 v2, 4, v1
  s_lshl_b32 s10, s8, 17
  s_add_u32 s10, s10, 0xa00000
  s_add_u32 s11, s9, s33
  s_lshl_b32 s12, s11, 15
  s_add_u32 s12, s12, 0xc00000
  s_lshl_b32 s34, s33, 11
  s_and_b32 s48, s8, 3
  s_lshl_b32 s48, s48, 1
  s_add_u32 s48, s48, s30
  s_and_b32 s48, s48, 0
  s_cmp_eq_u32 s33, 7
  s_waitcnt lgkmcnt(0)
  s_cbranch_scc1 K2_AUX
  s_add_u32 s16, s4, s10
  s_addc_u32 s17, s5, 0
  s_mov_b32 s18, 131072
  s_mov_b32 s19, 0x20000
  s_add_u32 s20, s4, s12
  s_addc_u32 s21, s5, 0
  s_mov_b32 s22, 32768
  s_mov_b32 s23, 0x20000
  s_lshl_b32 s35, s48, 14
  s_add_u32 s35, s35, s34
  s_mov_b32 m0, s34
  s_nop 0
  buffer_load_dwordx4 v2, s[16:19], s35 offen lds
  buffer_load_dwordx4 v2, s[16:19], s35 offen offset:1024 lds
  s_add_u32 s36, s48, 0
  s_and_b32 s36, s36, 7
  s_lshl_b32 s36, s36, 12
  buffer_load_dwordx4 v[128:131], v2, s[20:23], s36 offen offset:0
  buffer_load_dwordx4 v[132:135], v2, s[20:23], s36 offen offset:1024
  s_barrier
  v_lshrrev_b32 v12, 4, v1
  v_bfe_u32 v13, v1, 2, 2
  v_and_b32 v14, 3, v1
  v_lshl_add_u32 v15, v12, 3, v13
  v_lshlrev_b32 v15, 8, v15
  v_lshl_add_u32 v15, v14, 3, v15
  v_and_b32 v14, 1, v12
  v_lshl_add_u32 v14, v13, 1, v14
  v_lshl_add_u32 v4, v14, 5, v15
  v_xor_b32 v5, 32, v4
  v_xor_b32 v6, 64, v4
  v_xor_b32 v7, 96, v4
  v_xor_b32 v8, 128, v4
  v_xor_b32 v9, 160, v4
  v_xor_b32 v10, 192, v4
  v_xor_b32 v11, 224, v4
  buffer_load_dwordx4 v[136:139], v2, s[20:23], s36 offen offset:2048
  buffer_load_dwordx4 v[140:143], v2, s[20:23], s36 offen offset:3072
  s_add_u32 s36, s48, 1
  s_and_b32 s36, s36, 7
  s_lshl_b32 s36, s36, 12
  buffer_load_dwordx4 v[144:147], v2, s[20:23], s36 offen offset:0
  buffer_load_dwordx4 v[148:151], v2, s[20:23], s36 offen offset:1024
  v_and_b32 v13, 15, v1
  s_lshl_b32 s35, s33, 8
  s_add_u32 s35, s35, 135168
  v_lshl_add_u32 v14, v13, 3, s35
  s_mov_b32 s35, 131072
  v_lshl_add_u32 v13, v13, 5, s35
  v_cmp_gt_u32 s[40:41], 16, v1
  s_mul_i32 s12, s8, 448
  s_add_u32 s12, s12, s11
  s_lshl_b32 s12, s12, 10
  s_add_u32 s12, s12, 0x1200000
  s_add_u32 s14, s4, s12
  s_addc_u32 s15, s5, 0
  s_lshr_b32 s37, s30, 3
  s_lshl_b32 s37, s37, 2
  s_and_b32 s38, s30, 3
  s_add_u32 s37, s37, s38
  s_bfe_u32 s38, s30, 0x10002
  s_and_b32 s39, s33, 1
  s_bfe_u32 s42, s33, 0x10001
  s_lshr_b32 s43, s33, 2
  s_and_b32 s49, s30, 3
  s_mul_i32 s49, s49, 0
  s_mul_i32 s12, s37, 229376
  s_mul_i32 s13, s33, 14336
  s_add_u32 s12, s12, s13
  s_add_u32 s12, s12, 0x1000000
  s_add_u32 s24, s4, s12
  s_addc_u32 s25, s5, 0
  s_mov_b32 s26, 129024
  s_mov_b32 s27, 0x20000
  s_lshl_b32 s12, s43, 8
  v_xor_b32 v12, s12, v2
  s_mul_i32 s12, s39, 114688
  v_add_u32 v3, s12, v12
  s_sub_u32 s12, 114688, s12
  v_add_u32 v12, s12, v12
  s_waitcnt vmcnt(4)
  s_barrier
  s_setprio 2
  ds_read_b64_tr_b16 v[16:17], v4 offset:0
  ds_read_b64_tr_b16 v[18:19], v4 offset:1024
  ds_read_b64_tr_b16 v[20:21], v5 offset:0
  ds_read_b64_tr_b16 v[22:23], v5 offset:1024
  ds_read_b64_tr_b16 v[24:25], v6 offset:0
  ds_read_b64_tr_b16 v[26:27], v6 offset:1024
  ds_read_b64_tr_b16 v[28:29], v7 offset:0
  ds_read_b64_tr_b16 v[30:31], v7 offset:1024
  ds_read_b64_tr_b16 v[32:33], v8 offset:0
  ds_read_b64_tr_b16 v[34:35], v8 offset:1024
  ds_read_b64_tr_b16 v[36:37], v9 offset:0
  ds_read_b64_tr_b16 v[38:39], v9 offset:1024
  ds_read_b64_tr_b16 v[40:41], v10 offset:0
  ds_read_b64_tr_b16 v[42:43], v10 offset:1024
  ds_read_b64_tr_b16 v[44:45], v11 offset:0
  ds_read_b64_tr_b16 v[46:47], v11 offset:1024
  s_waitcnt lgkmcnt(8)
  v_mfma_f32_16x16x32_bf16 v[64:67], v[128:131], v[16:19], 0
  ds_read_b64_tr_b16 v[48:49], v4 offset:8192
  ds_read_b64_tr_b16 v[50:51], v4 offset:9216
  v_mfma_f32_16x16x32_bf16 v[68:71], v[132:135], v[16:19], 0
  ds_read_b64_tr_b16 v[52:53], v5 offset:8192
  ds_read_b64_tr_b16 v[54:55], v5 offset:9216
  v_mfma_f32_16x16x32_bf16 v[72:75], v[128:131], v[20:23], 0
  ds_read_b64_tr_b16 v[56:57], v6 offset:8192
  ds_read_b64_tr_b16 v[58:59], v6 offset:9216
  v_mfma_f32_16x16x32_bf16 v[76:79], v[132:135], v[20:23], 0
  ds_read_b64_tr_b16 v[60:61], v7 offset:8192
  ds_read_b64_tr_b16 v[62:63], v7 offset:9216
  v_mfma_f32_16x16x32_bf16 v[80:83], v[128:131], v[24:27], 0
  buffer_load_dwordx4 v[152:155], v2, s[20:23], s36 offen offset:2048
  v_mfma_f32_16x16x32_bf16 v[84:87], v[132:135], v[24:27], 0
  v_mfma_f32_16x16x32_bf16 v[88:91], v[128:131], v[28:31], 0
  v_mfma_f32_16x16x32_bf16 v[92:95], v[132:135], v[28:31], 0
  s_waitcnt lgkmcnt(8)
  v_mfma_f32_16x16x32_bf16 v[96:99], v[128:131], v[32:35], 0
  ds_read_b64_tr_b16 v[16:17], v8 offset:8192
  ds_read_b64_tr_b16 v[18:19], v8 offset:9216
  v_mfma_f32_16x16x32_bf16 v[100:103], v[132:135], v[32:35], 0
  ds_read_b64_tr_b16 v[20:21], v9 offset:8192
  ds_read_b64_tr_b16 v[22:23], v9 offset:9216
  v_mfma_f32_16x16x32_bf16 v[104:107], v[128:131], v[36:39], 0
  ds_read_b64_tr_b16 v[24:25], v10 offset:8192
  ds_read_b64_tr_b16 v[26:27], v10 offset:9216
  v_mfma_f32_16x16x32_bf16 v[108:111], v[132:135], v[36:39], 0
  ds_read_b64_tr_b16 v[28:29], v11 offset:8192
  ds_read_b64_tr_b16 v[30:31], v11 offset:9216
  v_mfma_f32_16x16x32_bf16 v[112:115], v[128:131], v[40:43], 0
  buffer_load_dwordx4 v[156:159], v2, s[20:23], s36 offen offset:3072
  v_mfma_f32_16x16x32_bf16 v[116:119], v[132:135], v[40:43], 0
  v_mfma_f32_16x16x32_bf16 v[120:123], v[128:131], v[44:47], 0
  v_mfma_f32_16x16x32_bf16 v[124:127], v[132:135], v[44:47], 0
  s_waitcnt vmcnt(4)
  s_barrier
  s_waitcnt lgkmcnt(8)
  v_mfma_f32_16x16x32_bf16 v[64:67], v[136:139], v[48:51], v[64:67]
  ds_read_b64_tr_b16 v[32:33], v4 offset:16384
  ds_read_b64_tr_b16 v[34:35], v4 offset:17408
  v_mfma_f32_16x16x32_bf16 v[68:71], v[140:143], v[48:51], v[68:71]
  ds_read_b64_tr_b16 v[36:37], v5 offset:16384
  ds_read_b64_tr_b16 v[38:39], v5 offset:17408
  v_mfma_f32_16x16x32_bf16 v[72:75], v[136:139], v[52:55], v[72:75]
  ds_read_b64_tr_b16 v[40:41], v6 offset:16384
  ds_read_b64_tr_b16 v[42:43], v6 offset:17408
  v_mfma_f32_16x16x32_bf16 v[76:79], v[140:143], v[52:55], v[76:79]
  ds_read_b64_tr_b16 v[44:45], v7 offset:16384
  ds_read_b64_tr_b16 v[46:47], v7 offset:17408
  v_mfma_f32_16x16x32_bf16 v[80:83], v[136:139], v[56:59], v[80:83]
  s_add_u32 s36, s48, 2
  s_and_b32 s36, s36, 7
  v_mfma_f32_16x16x32_bf16 v[84:87], v[140:143], v[56:59], v[84:87]
  s_lshl_b32 s36, s36, 12
  buffer_load_dwordx4 v[160:163], v2, s[20:23], s36 offen offset:0
  v_mfma_f32_16x16x32_bf16 v[88:91], v[136:139], v[60:63], v[88:91]
  v_mfma_f32_16x16x32_bf16 v[92:95], v[140:143], v[60:63], v[92:95]
  s_waitcnt lgkmcnt(8)
  v_mfma_f32_16x16x32_bf16 v[96:99], v[136:139], v[16:19], v[96:99]
  ds_read_b64_tr_b16 v[48:49], v8 offset:16384
  ds_read_b64_tr_b16 v[50:51], v8 offset:17408
  v_mfma_f32_16x16x32_bf16 v[100:103], v[140:143], v[16:19], v[100:103]
  ds_read_b64_tr_b16 v[52:53], v9 offset:16384
  ds_read_b64_tr_b16 v[54:55], v9 offset:17408
  v_mfma_f32_16x16x32_bf16 v[104:107], v[136:139], v[20:23], v[104:107]
  ds_read_b64_tr_b16 v[56:57], v10 offset:16384
  ds_read_b64_tr_b16 v[58:59], v10 offset:17408
  v_mfma_f32_16x16x32_bf16 v[108:111], v[140:143], v[20:23], v[108:111]
  ds_read_b64_tr_b16 v[60:61], v11 offset:16384
  ds_read_b64_tr_b16 v[62:63], v11 offset:17408
  v_mfma_f32_16x16x32_bf16 v[112:115], v[136:139], v[24:27], v[112:115]
  buffer_load_dwordx4 v[164:167], v2, s[20:23], s36 offen offset:1024
  v_mfma_f32_16x16x32_bf16 v[116:119], v[140:143], v[24:27], v[116:119]
  v_mfma_f32_16x16x32_bf16 v[120:123], v[136:139], v[28:31], v[120:123]
  v_mfma_f32_16x16x32_bf16 v[124:127], v[140:143], v[28:31], v[124:127]
  s_waitcnt vmcnt(4)
  s_waitcnt lgkmcnt(8)
  v_mfma_f32_16x16x32_bf16 v[64:67], v[144:147], v[32:35], v[64:67]
  ds_read_b64_tr_b16 v[16:17], v4 offset:24576
  ds_read_b64_tr_b16 v[18:19], v4 offset:25600
  v_mfma_f32_16x16x32_bf16 v[68:71], v[148:151], v[32:35], v[68:71]
  ds_read_b64_tr_b16 v[20:21], v5 offset:24576
  ds_read_b64_tr_b16 v[22:23], v5 offset:25600
  v_mfma_f32_16x16x32_bf16 v[72:75], v[144:147], v[36:39], v[72:75]
  ds_read_b64_tr_b16 v[24:25], v6 offset:24576
  ds_read_b64_tr_b16 v[26:27], v6 offset:25600
  v_mfma_f32_16x16x32_bf16 v[76:79], v[148:151], v[36:39], v[76:79]
  ds_read_b64_tr_b16 v[28:29], v7 offset:24576
  ds_read_b64_tr_b16 v[30:31], v7 offset:25600
  v_mfma_f32_16x16x32_bf16 v[80:83], v[144:147], v[40:43], v[80:83]
  buffer_load_dwordx4 v[168:171], v2, s[20:23], s36 offen offset:2048
  v_mfma_f32_16x16x32_bf16 v[84:87], v[148:151], v[40:43], v[84:87]
  v_mfma_f32_16x16x32_bf16 v[88:91], v[144:147], v[44:47], v[88:91]
  v_mfma_f32_16x16x32_bf16 v[92:95], v[148:151], v[44:47], v[92:95]
  s_waitcnt lgkmcnt(8)
  v_mfma_f32_16x16x32_bf16 v[96:99], v[144:147], v[48:51], v[96:99]
  ds_read_b64_tr_b16 v[32:33], v8 offset:24576
  ds_read_b64_tr_b16 v[34:35], v8 offset:25600
  v_mfma_f32_16x16x32_bf16 v[100:103], v[148:151], v[48:51], v[100:103]
  ds_read_b64_tr_b16 v[36:37], v9 offset:24576
  ds_read_b64_tr_b16 v[38:39], v9 offset:25600
  v_mfma_f32_16x16x32_bf16 v[104:107], v[144:147], v[52:55], v[104:107]
  ds_read_b64_tr_b16 v[40:41], v10 offset:24576
  ds_read_b64_tr_b16 v[42:43], v10 offset:25600
  v_mfma_f32_16x16x32_bf16 v[108:111], v[148:151], v[52:55], v[108:111]
  ds_read_b64_tr_b16 v[44:45], v11 offset:24576
  ds_read_b64_tr_b16 v[46:47], v11 offset:25600
  v_mfma_f32_16x16x32_bf16 v[112:115], v[144:147], v[56:59], v[112:115]
  buffer_load_dwordx4 v[172:175], v2, s[20:23], s36 offen offset:3072
  v_mfma_f32_16x16x32_bf16 v[116:119], v[148:151], v[56:59], v[116:119]
  v_mfma_f32_16x16x32_bf16 v[120:123], v[144:147], v[60:63], v[120:123]
  v_mfma_f32_16x16x32_bf16 v[124:127], v[148:151], v[60:63], v[124:127]
  s_waitcnt vmcnt(4)
  s_barrier
  s_waitcnt lgkmcnt(8)
  v_mfma_f32_16x16x32_bf16 v[64:67], v[152:155], v[16:19], v[64:67]
  ds_read_b64_tr_b16 v[48:49], v4 offset:32768
  ds_read_b64_tr_b16 v[50:51], v4 offset:33792
  v_mfma_f32_16x16x32_bf16 v[68:71], v[156:159], v[16:19], v[68:71]
  ds_read_b64_tr_b16 v[52:53], v5 offset:32768
  ds_read_b64_tr_b16 v[54:55], v5 offset:33792
  v_mfma_f32_16x16x32_bf16 v[72:75], v[152:155], v[20:23], v[72:75]
  ds_read_b64_tr_b16 v[56:57], v6 offset:32768
  ds_read_b64_tr_b16 v[58:59], v6 offset:33792
  v_mfma_f32_16x16x32_bf16 v[76:79], v[156:159], v[20:23], v[76:79]
  ds_read_b64_tr_b16 v[60:61], v7 offset:32768
  ds_read_b64_tr_b16 v[62:63], v7 offset:33792
  v_mfma_f32_16x16x32_bf16 v[80:83], v[152:155], v[24:27], v[80:83]
  s_add_u32 s36, s48, 3
  s_and_b32 s36, s36, 7
  v_mfma_f32_16x16x32_bf16 v[84:87], v[156:159], v[24:27], v[84:87]
  s_lshl_b32 s36, s36, 12
  buffer_load_dwordx4 v[176:179], v2, s[20:23], s36 offen offset:0
  v_mfma_f32_16x16x32_bf16 v[88:91], v[152:155], v[28:31], v[88:91]
  v_mfma_f32_16x16x32_bf16 v[92:95], v[156:159], v[28:31], v[92:95]
  s_waitcnt lgkmcnt(8)
  v_mfma_f32_16x16x32_bf16 v[96:99], v[152:155], v[32:35], v[96:99]
  ds_read_b64_tr_b16 v[16:17], v8 offset:32768
  ds_read_b64_tr_b16 v[18:19], v8 offset:33792
  v_mfma_f32_16x16x32_bf16 v[100:103], v[156:159], v[32:35], v[100:103]
  ds_read_b64_tr_b16 v[20:21], v9 offset:32768
  ds_read_b64_tr_b16 v[22:23], v9 offset:33792
  v_mfma_f32_16x16x32_bf16 v[104:107], v[152:155], v[36:39], v[104:107]
  ds_read_b64_tr_b16 v[24:25], v10 offset:32768
  ds_read_b64_tr_b16 v[26:27], v10 offset:33792
  v_mfma_f32_16x16x32_bf16 v[108:111], v[156:159], v[36:39], v[108:111]
  ds_read_b64_tr_b16 v[28:29], v11 offset:32768
  ds_read_b64_tr_b16 v[30:31], v11 offset:33792
  v_mfma_f32_16x16x32_bf16 v[112:115], v[152:155], v[40:43], v[112:115]
  buffer_load_dwordx4 v[180:183], v2, s[20:23], s36 offen offset:1024
  v_mfma_f32_16x16x32_bf16 v[116:119], v[156:159], v[40:43], v[116:119]
  v_mfma_f32_16x16x32_bf16 v[120:123], v[152:155], v[44:47], v[120:123]
  v_mfma_f32_16x16x32_bf16 v[124:127], v[156:159], v[44:47], v[124:127]
  s_waitcnt vmcnt(4)
  s_waitcnt lgkmcnt(8)
  v_mfma_f32_16x16x32_bf16 v[64:67], v[160:163], v[48:51], v[64:67]
  ds_read_b64_tr_b16 v[32:33], v4 offset:40960
  ds_read_b64_tr_b16 v[34:35], v4 offset:41984
  v_mfma_f32_16x16x32_bf16 v[68:71], v[164:167], v[48:51], v[68:71]
  ds_read_b64_tr_b16 v[36:37], v5 offset:40960
  ds_read_b64_tr_b16 v[38:39], v5 offset:41984
  v_mfma_f32_16x16x32_bf16 v[72:75], v[160:163], v[52:55], v[72:75]
  ds_read_b64_tr_b16 v[40:41], v6 offset:40960
  ds_read_b64_tr_b16 v[42:43], v6 offset:41984
  v_mfma_f32_16x16x32_bf16 v[76:79], v[164:167], v[52:55], v[76:79]
  ds_read_b64_tr_b16 v[44:45], v7 offset:40960
  ds_read_b64_tr_b16 v[46:47], v7 offset:41984
  v_mfma_f32_16x16x32_bf16 v[80:83], v[160:163], v[56:59], v[80:83]
  buffer_load_dwordx4 v[184:187], v2, s[20:23], s36 offen offset:2048
  v_mfma_f32_16x16x32_bf16 v[84:87], v[164:167], v[56:59], v[84:87]
  v_mfma_f32_16x16x32_bf16 v[88:91], v[160:163], v[60:63], v[88:91]
  v_mfma_f32_16x16x32_bf16 v[92:95], v[164:167], v[60:63], v[92:95]
  s_waitcnt lgkmcnt(8)
  v_mfma_f32_16x16x32_bf16 v[96:99], v[160:163], v[16:19], v[96:99]
  ds_read_b64_tr_b16 v[48:49], v8 offset:40960
  ds_read_b64_tr_b16 v[50:51], v8 offset:41984
  v_mfma_f32_16x16x32_bf16 v[100:103], v[164:167], v[16:19], v[100:103]
  ds_read_b64_tr_b16 v[52:53], v9 offset:40960
  ds_read_b64_tr_b16 v[54:55], v9 offset:41984
  v_mfma_f32_16x16x32_bf16 v[104:107], v[160:163], v[20:23], v[104:107]
  ds_read_b64_tr_b16 v[56:57], v10 offset:40960
  ds_read_b64_tr_b16 v[58:59], v10 offset:41984
  v_mfma_f32_16x16x32_bf16 v[108:111], v[164:167], v[20:23], v[108:111]
  ds_read_b64_tr_b16 v[60:61], v11 offset:40960
  ds_read_b64_tr_b16 v[62:63], v11 offset:41984
  v_mfma_f32_16x16x32_bf16 v[112:115], v[160:163], v[24:27], v[112:115]
  buffer_load_dwordx4 v[188:191], v2, s[20:23], s36 offen offset:3072
  v_mfma_f32_16x16x32_bf16 v[116:119], v[164:167], v[24:27], v[116:119]
  v_mfma_f32_16x16x32_bf16 v[120:123], v[160:163], v[28:31], v[120:123]
  v_mfma_f32_16x16x32_bf16 v[124:127], v[164:167], v[28:31], v[124:127]
  s_waitcnt vmcnt(4)
  s_barrier
  s_waitcnt lgkmcnt(8)
  v_mfma_f32_16x16x32_bf16 v[64:67], v[168:171], v[32:35], v[64:67]
  ds_read_b64_tr_b16 v[16:17], v4 offset:49152
  ds_read_b64_tr_b16 v[18:19], v4 offset:50176
  v_mfma_f32_16x16x32_bf16 v[68:71], v[172:175], v[32:35], v[68:71]
  ds_read_b64_tr_b16 v[20:21], v5 offset:49152
  ds_read_b64_tr_b16 v[22:23], v5 offset:50176
  v_mfma_f32_16x16x32_bf16 v[72:75], v[168:171], v[36:39], v[72:75]
  ds_read_b64_tr_b16 v[24:25], v6 offset:49152
  ds_read_b64_tr_b16 v[26:27], v6 offset:50176
  v_mfma_f32_16x16x32_bf16 v[76:79], v[172:175], v[36:39], v[76:79]
  ds_read_b64_tr_b16 v[28:29], v7 offset:49152
  ds_read_b64_tr_b16 v[30:31], v7 offset:50176
  v_mfma_f32_16x16x32_bf16 v[80:83], v[168:171], v[40:43], v[80:83]
  s_add_u32 s36, s48, 4
  s_and_b32 s36, s36, 7
  v_mfma_f32_16x16x32_bf16 v[84:87], v[172:175], v[40:43], v[84:87]
  s_lshl_b32 s36, s36, 12
  buffer_load_dwordx4 v[192:195], v2, s[20:23], s36 offen offset:0
  v_mfma_f32_16x16x32_bf16 v[88:91], v[168:171], v[44:47], v[88:91]
  v_mfma_f32_16x16x32_bf16 v[92:95], v[172:175], v[44:47], v[92:95]
  s_waitcnt lgkmcnt(8)
  v_mfma_f32_16x16x32_bf16 v[96:99], v[168:171], v[48:51], v[96:99]
  ds_read_b64_tr_b16 v[32:33], v8 offset:49152
  ds_read_b64_tr_b16 v[34:35], v8 offset:50176
  v_mfma_f32_16x16x32_bf16 v[100:103], v[172:175], v[48:51], v[100:103]
  ds_read_b64_tr_b16 v[36:37], v9 offset:49152
  ds_read_b64_tr_b16 v[38:39], v9 offset:50176
  v_mfma_f32_16x16x32_bf16 v[104:107], v[168:171], v[52:55], v[104:107]
  ds_read_b64_tr_b16 v[40:41], v10 offset:49152
  ds_read_b64_tr_b16 v[42:43], v10 offset:50176
  v_mfma_f32_16x16x32_bf16 v[108:111], v[172:175], v[52:55], v[108:111]
  ds_read_b64_tr_b16 v[44:45], v11 offset:49152
  ds_read_b64_tr_b16 v[46:47], v11 offset:50176
  v_mfma_f32_16x16x32_bf16 v[112:115], v[168:171], v[56:59], v[112:115]
  buffer_load_dwordx4 v[196:199], v2, s[20:23], s36 offen offset:1024
  v_mfma_f32_16x16x32_bf16 v[116:119], v[172:175], v[56:59], v[116:119]
  v_mfma_f32_16x16x32_bf16 v[120:123], v[168:171], v[60:63], v[120:123]
  v_mfma_f32_16x16x32_bf16 v[124:127], v[172:175], v[60:63], v[124:127]
  s_waitcnt vmcnt(4)
  s_waitcnt lgkmcnt(8)
  v_mfma_f32_16x16x32_bf16 v[64:67], v[176:179], v[16:19], v[64:67]
  ds_read_b64_tr_b16 v[48:49], v4 offset:57344
  ds_read_b64_tr_b16 v[50:51], v4 offset:58368
  v_mfma_f32_16x16x32_bf16 v[68:71], v[180:183], v[16:19], v[68:71]
  ds_read_b64_tr_b16 v[52:53], v5 offset:57344
  ds_read_b64_tr_b16 v[54:55], v5 offset:58368
  v_mfma_f32_16x16x32_bf16 v[72:75], v[176:179], v[20:23], v[72:75]
  ds_read_b64_tr_b16 v[56:57], v6 offset:57344
  ds_read_b64_tr_b16 v[58:59], v6 offset:58368
  v_mfma_f32_16x16x32_bf16 v[76:79], v[180:183], v[20:23], v[76:79]
  ds_read_b64_tr_b16 v[60:61], v7 offset:57344
  ds_read_b64_tr_b16 v[62:63], v7 offset:58368
  v_mfma_f32_16x16x32_bf16 v[80:83], v[176:179], v[24:27], v[80:83]
  buffer_load_dwordx4 v[200:203], v2, s[20:23], s36 offen offset:2048
  v_mfma_f32_16x16x32_bf16 v[84:87], v[180:183], v[24:27], v[84:87]
  v_mfma_f32_16x16x32_bf16 v[88:91], v[176:179], v[28:31], v[88:91]
  v_mfma_f32_16x16x32_bf16 v[92:95], v[180:183], v[28:31], v[92:95]
  s_waitcnt lgkmcnt(8)
  v_mfma_f32_16x16x32_bf16 v[96:99], v[176:179], v[32:35], v[96:99]
  ds_read_b64_tr_b16 v[16:17], v8 offset:57344
  ds_read_b64_tr_b16 v[18:19], v8 offset:58368
  v_mfma_f32_16x16x32_bf16 v[100:103], v[180:183], v[32:35], v[100:103]
  ds_read_b64_tr_b16 v[20:21], v9 offset:57344
  ds_read_b64_tr_b16 v[22:23], v9 offset:58368
  v_mfma_f32_16x16x32_bf16 v[104:107], v[176:179], v[36:39], v[104:107]
  ds_read_b64_tr_b16 v[24:25], v10 offset:57344
  ds_read_b64_tr_b16 v[26:27], v10 offset:58368
  v_mfma_f32_16x16x32_bf16 v[108:111], v[180:183], v[36:39], v[108:111]
  ds_read_b64_tr_b16 v[28:29], v11 offset:57344
  ds_read_b64_tr_b16 v[30:31], v11 offset:58368
  v_mfma_f32_16x16x32_bf16 v[112:115], v[176:179], v[40:43], v[112:115]
  buffer_load_dwordx4 v[204:207], v2, s[20:23], s36 offen offset:3072
  v_mfma_f32_16x16x32_bf16 v[116:119], v[180:183], v[40:43], v[116:119]
  v_mfma_f32_16x16x32_bf16 v[120:123], v[176:179], v[44:47], v[120:123]
  v_mfma_f32_16x16x32_bf16 v[124:127], v[180:183], v[44:47], v[124:127]
  s_waitcnt vmcnt(4)
  s_barrier
  s_waitcnt lgkmcnt(8)
  v_mfma_f32_16x16x32_bf16 v[64:67], v[184:187], v[48:51], v[64:67]
  v_add_u32 v4, 0x10000, v4
  v_add_u32 v5, 0x10000, v5
  v_mfma_f32_16x16x32_bf16 v[68:71], v[188:191], v[48:51], v[68:71]
  v_add_u32 v6, 0x10000, v6
  v_add_u32 v7, 0x10000, v7
  v_mfma_f32_16x16x32_bf16 v[72:75], v[184:187], v[52:55], v[72:75]
  ds_read_b64_tr_b16 v[32:33], v4 offset:0
  ds_read_b64_tr_b16 v[34:35], v4 offset:1024
  v_mfma_f32_16x16x32_bf16 v[76:79], v[188:191], v[52:55], v[76:79]
  ds_read_b64_tr_b16 v[36:37], v5 offset:0
  ds_read_b64_tr_b16 v[38:39], v5 offset:1024
  v_mfma_f32_16x16x32_bf16 v[80:83], v[184:187], v[56:59], v[80:83]
  ds_read_b64_tr_b16 v[40:41], v6 offset:0
  ds_read_b64_tr_b16 v[42:43], v6 offset:1024
  v_mfma_f32_16x16x32_bf16 v[84:87], v[188:191], v[56:59], v[84:87]
  ds_read_b64_tr_b16 v[44:45], v7 offset:0
  ds_read_b64_tr_b16 v[46:47], v7 offset:1024
  v_mfma_f32_16x16x32_bf16 v[88:91], v[184:187], v[60:63], v[88:91]
  s_add_u32 s36, s48, 5
  s_and_b32 s36, s36, 7
  v_mfma_f32_16x16x32_bf16 v[92:95], v[188:191], v[60:63], v[92:95]
  s_lshl_b32 s36, s36, 12
  buffer_load_dwordx4 v[208:211], v2, s[20:23], s36 offen offset:0
  s_add_u32 s44, s49, 5120
  s_sub_u32 s47, s44, 14336
  s_cselect_b32 s44, s44, s47
  buffer_load_dwordx4 v[168:171], v3, s[24:27], s44 offen
  buffer_load_dwordx4 v[172:175], v12, s[24:27], s44 offen
  s_waitcnt lgkmcnt(8)
  v_mfma_f32_16x16x32_bf16 v[96:99], v[184:187], v[16:19], v[96:99]
  v_add_u32 v8, 0x10000, v8
  v_add_u32 v9, 0x10000, v9
  v_mfma_f32_16x16x32_bf16 v[100:103], v[188:191], v[16:19], v[100:103]
  v_add_u32 v10, 0x10000, v10
  v_add_u32 v11, 0x10000, v11
  v_mfma_f32_16x16x32_bf16 v[104:107], v[184:187], v[20:23], v[104:107]
  ds_read_b64_tr_b16 v[48:49], v8 offset:0
  ds_read_b64_tr_b16 v[50:51], v8 offset:1024
  v_mfma_f32_16x16x32_bf16 v[108:111], v[188:191], v[20:23], v[108:111]
  ds_read_b64_tr_b16 v[52:53], v9 offset:0
  ds_read_b64_tr_b16 v[54:55], v9 offset:1024
  v_mfma_f32_16x16x32_bf16 v[112:115], v[184:187], v[24:27], v[112:115]
  ds_read_b64_tr_b16 v[56:57], v10 offset:0
  ds_read_b64_tr_b16 v[58:59], v10 offset:1024
  v_mfma_f32_16x16x32_bf16 v[116:119], v[188:191], v[24:27], v[116:119]
  ds_read_b64_tr_b16 v[60:61], v11 offset:0
  ds_read_b64_tr_b16 v[62:63], v11 offset:1024
  v_mfma_f32_16x16x32_bf16 v[120:123], v[184:187], v[28:31], v[120:123]
  buffer_load_dwordx4 v[212:215], v2, s[20:23], s36 offen offset:1024
  v_mfma_f32_16x16x32_bf16 v[124:127], v[188:191], v[28:31], v[124:127]
  s_waitcnt vmcnt(6)
  s_waitcnt lgkmcnt(8)
  v_mfma_f32_16x16x32_bf16 v[64:67], v[192:195], v[32:35], v[64:67]
  ds_read_b64_tr_b16 v[16:17], v4 offset:8192
  ds_read_b64_tr_b16 v[18:19], v4 offset:9216
  v_mfma_f32_16x16x32_bf16 v[68:71], v[196:199], v[32:35], v[68:71]
  ds_read_b64_tr_b16 v[20:21], v5 offset:8192
  ds_read_b64_tr_b16 v[22:23], v5 offset:9216
  v_mfma_f32_16x16x32_bf16 v[72:75], v[192:195], v[36:39], v[72:75]
  ds_read_b64_tr_b16 v[24:25], v6 offset:8192
  ds_read_b64_tr_b16 v[26:27], v6 offset:9216
  v_mfma_f32_16x16x32_bf16 v[76:79], v[196:199], v[36:39], v[76:79]
  ds_read_b64_tr_b16 v[28:29], v7 offset:8192
  ds_read_b64_tr_b16 v[30:31], v7 offset:9216
  v_mfma_f32_16x16x32_bf16 v[80:83], v[192:195], v[40:43], v[80:83]
  buffer_load_dwordx4 v[216:219], v2, s[20:23], s36 offen offset:2048
  s_add_u32 s44, s49, 6144
  v_mfma_f32_16x16x32_bf16 v[84:87], v[196:199], v[40:43], v[84:87]
  s_sub_u32 s47, s44, 14336
  s_cselect_b32 s44, s44, s47
  v_mfma_f32_16x16x32_bf16 v[88:91], v[192:195], v[44:47], v[88:91]
  buffer_load_dwordx4 v[176:179], v3, s[24:27], s44 offen
  buffer_load_dwordx4 v[180:183], v12, s[24:27], s44 offen
  v_mfma_f32_16x16x32_bf16 v[92:95], v[196:199], v[44:47], v[92:95]
  s_waitcnt lgkmcnt(8)
  v_mfma_f32_16x16x32_bf16 v[96:99], v[192:195], v[48:51], v[96:99]
  ds_read_b64_tr_b16 v[32:33], v8 offset:8192
  ds_read_b64_tr_b16 v[34:35], v8 offset:9216
  v_mfma_f32_16x16x32_bf16 v[100:103], v[196:199], v[48:51], v[100:103]
  ds_read_b64_tr_b16 v[36:37], v9 offset:8192
  ds_read_b64_tr_b16 v[38:39], v9 offset:9216
  v_mfma_f32_16x16x32_bf16 v[104:107], v[192:195], v[52:55], v[104:107]
  ds_read_b64_tr_b16 v[40:41], v10 offset:8192
  ds_read_b64_tr_b16 v[42:43], v10 offset:9216
  v_mfma_f32_16x16x32_bf16 v[108:111], v[196:199], v[52:55], v[108:111]
  ds_read_b64_tr_b16 v[44:45], v11 offset:8192
  ds_read_b64_tr_b16 v[46:47], v11 offset:9216
  v_mfma_f32_16x16x32_bf16 v[112:115], v[192:195], v[56:59], v[112:115]
  buffer_load_dwordx4 v[220:223], v2, s[20:23], s36 offen offset:3072
  v_mfma_f32_16x16x32_bf16 v[116:119], v[196:199], v[56:59], v[116:119]
  v_mfma_f32_16x16x32_bf16 v[120:123], v[192:195], v[60:63], v[120:123]
  v_mfma_f32_16x16x32_bf16 v[124:127], v[196:199], v[60:63], v[124:127]
  s_waitcnt vmcnt(8)
  s_barrier
  ds_read_b64 v[160:161], v14
  ds_read_b64 v[164:165], v14 offset:128
  ds_read_b128 v[128:131], v13 offset:0
  ds_read_b128 v[132:135], v13 offset:512
  ds_read_b128 v[136:139], v13 offset:1024
  ds_read_b128 v[140:143], v13 offset:1536
  ds_read_b128 v[144:147], v13 offset:2048
  ds_read_b128 v[148:151], v13 offset:2560
  ds_read_b128 v[152:155], v13 offset:3072
  ds_read_b128 v[156:159], v13 offset:3584
  v_pk_mov_b32 v[162:163], 0, 0
  v_pk_mov_b32 v[166:167], 0, 0
  s_waitcnt lgkmcnt(8)
  v_cndmask_b32 v160, 0, v160, s[40:41]
  v_cndmask_b32 v161, 0, v161, s[40:41]
  v_cndmask_b32 v164, 0, v164, s[40:41]
  v_cndmask_b32 v165, 0, v165, s[40:41]
  s_waitcnt lgkmcnt(0)
  v_mfma_f32_16x16x32_bf16 v[64:67], v[160:163], v[128:131], v[64:67]
  v_mfma_f32_16x16x32_bf16 v[68:71], v[164:167], v[128:131], v[68:71]
  v_mfma_f32_16x16x32_bf16 v[72:75], v[160:163], v[132:135], v[72:75]
  v_mfma_f32_16x16x32_bf16 v[76:79], v[164:167], v[132:135], v[76:79]
  v_mfma_f32_16x16x32_bf16 v[80:83], v[160:163], v[136:139], v[80:83]
  v_mfma_f32_16x16x32_bf16 v[84:87], v[164:167], v[136:139], v[84:87]
  v_mfma_f32_16x16x32_bf16 v[88:91], v[160:163], v[140:143], v[88:91]
  v_mfma_f32_16x16x32_bf16 v[92:95], v[164:167], v[140:143], v[92:95]
  v_mfma_f32_16x16x32_bf16 v[96:99], v[160:163], v[144:147], v[96:99]
  v_mfma_f32_16x16x32_bf16 v[100:103], v[164:167], v[144:147], v[100:103]
  v_mfma_f32_16x16x32_bf16 v[104:107], v[160:163], v[148:151], v[104:107]
  v_mfma_f32_16x16x32_bf16 v[108:111], v[164:167], v[148:151], v[108:111]
  v_mfma_f32_16x16x32_bf16 v[112:115], v[160:163], v[152:155], v[112:115]
  v_mfma_f32_16x16x32_bf16 v[116:119], v[164:167], v[152:155], v[116:119]
  v_mfma_f32_16x16x32_bf16 v[120:123], v[160:163], v[156:159], v[120:123]
  v_mfma_f32_16x16x32_bf16 v[124:127], v[164:167], v[156:159], v[124:127]
  s_waitcnt lgkmcnt(8)
  v_mfma_f32_16x16x32_bf16 v[64:67], v[200:203], v[16:19], v[64:67]
  ds_read_b64_tr_b16 v[48:49], v4 offset:16384
  ds_read_b64_tr_b16 v[50:51], v4 offset:17408
  v_mfma_f32_16x16x32_bf16 v[68:71], v[204:207], v[16:19], v[68:71]
  ds_read_b64_tr_b16 v[52:53], v5 offset:16384
  ds_read_b64_tr_b16 v[54:55], v5 offset:17408
  v_mfma_f32_16x16x32_bf16 v[72:75], v[200:203], v[20:23], v[72:75]
  ds_read_b64_tr_b16 v[56:57], v6 offset:16384
  ds_read_b64_tr_b16 v[58:59], v6 offset:17408
  v_mfma_f32_16x16x32_bf16 v[76:79], v[204:207], v[20:23], v[76:79]
  ds_read_b64_tr_b16 v[60:61], v7 offset:16384
  ds_read_b64_tr_b16 v[62:63], v7 offset:17408
  v_mfma_f32_16x16x32_bf16 v[80:83], v[200:203], v[24:27], v[80:83]
  s_add_u32 s36, s48, 6
  s_and_b32 s36, s36, 7
  v_mfma_f32_16x16x32_bf16 v[84:87], v[204:207], v[24:27], v[84:87]
  s_lshl_b32 s36, s36, 12
  buffer_load_dwordx4 v[224:227], v2, s[20:23], s36 offen offset:0
  v_mfma_f32_16x16x32_bf16 v[88:91], v[200:203], v[28:31], v[88:91]
  s_add_u32 s44, s49, 7168
  s_sub_u32 s47, s44, 14336
  v_mfma_f32_16x16x32_bf16 v[92:95], v[204:207], v[28:31], v[92:95]
  s_cselect_b32 s44, s44, s47
  buffer_load_dwordx4 v[184:187], v3, s[24:27], s44 offen
  buffer_load_dwordx4 v[188:191], v12, s[24:27], s44 offen
  s_waitcnt lgkmcnt(8)
  v_mfma_f32_16x16x32_bf16 v[96:99], v[200:203], v[32:35], v[96:99]
  ds_read_b64_tr_b16 v[16:17], v8 offset:16384
  ds_read_b64_tr_b16 v[18:19], v8 offset:17408
  v_mfma_f32_16x16x32_bf16 v[100:103], v[204:207], v[32:35], v[100:103]
  ds_read_b64_tr_b16 v[20:21], v9 offset:16384
  ds_read_b64_tr_b16 v[22:23], v9 offset:17408
  v_mfma_f32_16x16x32_bf16 v[104:107], v[200:203], v[36:39], v[104:107]
  ds_read_b64_tr_b16 v[24:25], v10 offset:16384
  ds_read_b64_tr_b16 v[26:27], v10 offset:17408
  v_mfma_f32_16x16x32_bf16 v[108:111], v[204:207], v[36:39], v[108:111]
  ds_read_b64_tr_b16 v[28:29], v11 offset:16384
  ds_read_b64_tr_b16 v[30:31], v11 offset:17408
  v_mfma_f32_16x16x32_bf16 v[112:115], v[200:203], v[40:43], v[112:115]
  buffer_load_dwordx4 v[228:231], v2, s[20:23], s36 offen offset:1024
  v_mfma_f32_16x16x32_bf16 v[116:119], v[204:207], v[40:43], v[116:119]
  v_mfma_f32_16x16x32_bf16 v[120:123], v[200:203], v[44:47], v[120:123]
  v_mfma_f32_16x16x32_bf16 v[124:127], v[204:207], v[44:47], v[124:127]
  s_waitcnt vmcnt(8)
  s_waitcnt lgkmcnt(8)
  v_mfma_f32_16x16x32_bf16 v[64:67], v[208:211], v[48:51], v[64:67]
  ds_read_b64_tr_b16 v[32:33], v4 offset:24576
  ds_read_b64_tr_b16 v[34:35], v4 offset:25600
  v_mfma_f32_16x16x32_bf16 v[68:71], v[212:215], v[48:51], v[68:71]
  ds_read_b64_tr_b16 v[36:37], v5 offset:24576
  ds_read_b64_tr_b16 v[38:39], v5 offset:25600
  v_mfma_f32_16x16x32_bf16 v[72:75], v[208:211], v[52:55], v[72:75]
  ds_read_b64_tr_b16 v[40:41], v6 offset:24576
  ds_read_b64_tr_b16 v[42:43], v6 offset:25600
  v_mfma_f32_16x16x32_bf16 v[76:79], v[212:215], v[52:55], v[76:79]
  ds_read_b64_tr_b16 v[44:45], v7 offset:24576
  ds_read_b64_tr_b16 v[46:47], v7 offset:25600
  v_mfma_f32_16x16x32_bf16 v[80:83], v[208:211], v[56:59], v[80:83]
  buffer_load_dwordx4 v[232:235], v2, s[20:23], s36 offen offset:2048
  s_add_u32 s44, s49, 0
  v_mfma_f32_16x16x32_bf16 v[84:87], v[212:215], v[56:59], v[84:87]
  s_sub_u32 s47, s44, 14336
  s_cselect_b32 s44, s44, s47
  v_mfma_f32_16x16x32_bf16 v[88:91], v[208:211], v[60:63], v[88:91]
  buffer_load_dwordx4 v[128:131], v3, s[24:27], s44 offen
  buffer_load_dwordx4 v[132:135], v12, s[24:27], s44 offen
  v_mfma_f32_16x16x32_bf16 v[92:95], v[212:215], v[60:63], v[92:95]
  s_waitcnt lgkmcnt(8)
  v_mfma_f32_16x16x32_bf16 v[96:99], v[208:211], v[16:19], v[96:99]
  ds_read_b64_tr_b16 v[48:49], v8 offset:24576
  ds_read_b64_tr_b16 v[50:51], v8 offset:25600
  v_mfma_f32_16x16x32_bf16 v[100:103], v[212:215], v[16:19], v[100:103]
  ds_read_b64_tr_b16 v[52:53], v9 offset:24576
  ds_read_b64_tr_b16 v[54:55], v9 offset:25600
  v_mfma_f32_16x16x32_bf16 v[104:107], v[208:211], v[20:23], v[104:107]
  ds_read_b64_tr_b16 v[56:57], v10 offset:24576
  ds_read_b64_tr_b16 v[58:59], v10 offset:25600
  v_mfma_f32_16x16x32_bf16 v[108:111], v[212:215], v[20:23], v[108:111]
  ds_read_b64_tr_b16 v[60:61], v11 offset:24576
  ds_read_b64_tr_b16 v[62:63], v11 offset:25600
  v_mfma_f32_16x16x32_bf16 v[112:115], v[208:211], v[24:27], v[112:115]
  buffer_load_dwordx4 v[236:239], v2, s[20:23], s36 offen offset:3072
  v_mfma_f32_16x16x32_bf16 v[116:119], v[212:215], v[24:27], v[116:119]
  v_mfma_f32_16x16x32_bf16 v[120:123], v[208:211], v[28:31], v[120:123]
  v_mfma_f32_16x16x32_bf16 v[124:127], v[212:215], v[28:31], v[124:127]
  s_waitcnt vmcnt(8)
  s_waitcnt lgkmcnt(8)
  v_mfma_f32_16x16x32_bf16 v[64:67], v[216:219], v[32:35], v[64:67]
  ds_read_b64_tr_b16 v[16:17], v4 offset:32768
  ds_read_b64_tr_b16 v[18:19], v4 offset:33792
  v_mfma_f32_16x16x32_bf16 v[68:71], v[220:223], v[32:35], v[68:71]
  ds_read_b64_tr_b16 v[20:21], v5 offset:32768
  ds_read_b64_tr_b16 v[22:23], v5 offset:33792
  v_mfma_f32_16x16x32_bf16 v[72:75], v[216:219], v[36:39], v[72:75]
  ds_read_b64_tr_b16 v[24:25], v6 offset:32768
  ds_read_b64_tr_b16 v[26:27], v6 offset:33792
  v_mfma_f32_16x16x32_bf16 v[76:79], v[220:223], v[36:39], v[76:79]
  ds_read_b64_tr_b16 v[28:29], v7 offset:32768
  ds_read_b64_tr_b16 v[30:31], v7 offset:33792
  v_mfma_f32_16x16x32_bf16 v[80:83], v[216:219], v[40:43], v[80:83]
  s_add_u32 s36, s48, 7
  s_and_b32 s36, s36, 7
  v_mfma_f32_16x16x32_bf16 v[84:87], v[220:223], v[40:43], v[84:87]
  s_lshl_b32 s36, s36, 12
  buffer_load_dwordx4 v[240:243], v2, s[20:23], s36 offen offset:0
  v_mfma_f32_16x16x32_bf16 v[88:91], v[216:219], v[44:47], v[88:91]
  s_add_u32 s44, s49, 1024
  s_sub_u32 s47, s44, 14336
  v_mfma_f32_16x16x32_bf16 v[92:95], v[220:223], v[44:47], v[92:95]
  s_cselect_b32 s44, s44, s47
  buffer_load_dwordx4 v[136:139], v3, s[24:27], s44 offen
  buffer_load_dwordx4 v[140:143], v12, s[24:27], s44 offen
  s_waitcnt lgkmcnt(8)
  v_mfma_f32_16x16x32_bf16 v[96:99], v[216:219], v[48:51], v[96:99]
  ds_read_b64_tr_b16 v[32:33], v8 offset:32768
  ds_read_b64_tr_b16 v[34:35], v8 offset:33792
  v_mfma_f32_16x16x32_bf16 v[100:103], v[220:223], v[48:51], v[100:103]
  ds_read_b64_tr_b16 v[36:37], v9 offset:32768
  ds_read_b64_tr_b16 v[38:39], v9 offset:33792
  v_mfma_f32_16x16x32_bf16 v[104:107], v[216:219], v[52:55], v[104:107]
  ds_read_b64_tr_b16 v[40:41], v10 offset:32768
  ds_read_b64_tr_b16 v[42:43], v10 offset:33792
  v_mfma_f32_16x16x32_bf16 v[108:111], v[220:223], v[52:55], v[108:111]
  ds_read_b64_tr_b16 v[44:45], v11 offset:32768
  ds_read_b64_tr_b16 v[46:47], v11 offset:33792
  v_mfma_f32_16x16x32_bf16 v[112:115], v[216:219], v[56:59], v[112:115]
  buffer_load_dwordx4 v[244:247], v2, s[20:23], s36 offen offset:1024
  v_mfma_f32_16x16x32_bf16 v[116:119], v[220:223], v[56:59], v[116:119]
  v_mfma_f32_16x16x32_bf16 v[120:123], v[216:219], v[60:63], v[120:123]
  v_mfma_f32_16x16x32_bf16 v[124:127], v[220:223], v[60:63], v[124:127]
  s_waitcnt vmcnt(8)
  s_waitcnt lgkmcnt(8)
  v_mfma_f32_16x16x32_bf16 v[64:67], v[224:227], v[16:19], v[64:67]
  ds_read_b64_tr_b16 v[48:49], v4 offset:40960
  ds_read_b64_tr_b16 v[50:51], v4 offset:41984
  v_mfma_f32_16x16x32_bf16 v[68:71], v[228:231], v[16:19], v[68:71]
  ds_read_b64_tr_b16 v[52:53], v5 offset:40960
  ds_read_b64_tr_b16 v[54:55], v5 offset:41984
  v_mfma_f32_16x16x32_bf16 v[72:75], v[224:227], v[20:23], v[72:75]
  ds_read_b64_tr_b16 v[56:57], v6 offset:40960
  ds_read_b64_tr_b16 v[58:59], v6 offset:41984
  v_mfma_f32_16x16x32_bf16 v[76:79], v[228:231], v[20:23], v[76:79]
  ds_read_b64_tr_b16 v[60:61], v7 offset:40960
  ds_read_b64_tr_b16 v[62:63], v7 offset:41984
  v_mfma_f32_16x16x32_bf16 v[80:83], v[224:227], v[24:27], v[80:83]
  buffer_load_dwordx4 v[248:251], v2, s[20:23], s36 offen offset:2048
  s_add_u32 s44, s49, 2048
  v_mfma_f32_16x16x32_bf16 v[84:87], v[228:231], v[24:27], v[84:87]
  s_sub_u32 s47, s44, 14336
  s_cselect_b32 s44, s44, s47
  v_mfma_f32_16x16x32_bf16 v[88:91], v[224:227], v[28:31], v[88:91]
  buffer_load_dwordx4 v[144:147], v3, s[24:27], s44 offen
  buffer_load_dwordx4 v[148:151], v12, s[24:27], s44 offen
  v_mfma_f32_16x16x32_bf16 v[92:95], v[228:231], v[28:31], v[92:95]
  s_waitcnt lgkmcnt(8)
  v_mfma_f32_16x16x32_bf16 v[96:99], v[224:227], v[32:35], v[96:99]
  ds_read_b64_tr_b16 v[16:17], v8 offset:40960
  ds_read_b64_tr_b16 v[18:19], v8 offset:41984
  v_mfma_f32_16x16x32_bf16 v[100:103], v[228:231], v[32:35], v[100:103]
  ds_read_b64_tr_b16 v[20:21], v9 offset:40960
  ds_read_b64_tr_b16 v[22:23], v9 offset:41984
  v_mfma_f32_16x16x32_bf16 v[104:107], v[224:227], v[36:39], v[104:107]
  ds_read_b64_tr_b16 v[24:25], v10 offset:40960
  ds_read_b64_tr_b16 v[26:27], v10 offset:41984
  v_mfma_f32_16x16x32_bf16 v[108:111], v[228:231], v[36:39], v[108:111]
  ds_read_b64_tr_b16 v[28:29], v11 offset:40960
  ds_read_b64_tr_b16 v[30:31], v11 offset:41984
  v_mfma_f32_16x16x32_bf16 v[112:115], v[224:227], v[40:43], v[112:115]
  buffer_load_dwordx4 v[252:255], v2, s[20:23], s36 offen offset:3072
  v_mfma_f32_16x16x32_bf16 v[116:119], v[228:231], v[40:43], v[116:119]
  v_mfma_f32_16x16x32_bf16 v[120:123], v[224:227], v[44:47], v[120:123]
  v_mfma_f32_16x16x32_bf16 v[124:127], v[228:231], v[44:47], v[124:127]
  s_waitcnt vmcnt(8)
  s_waitcnt lgkmcnt(8)
  v_mfma_f32_16x16x32_bf16 v[64:67], v[232:235], v[48:51], v[64:67]
  ds_read_b64_tr_b16 v[32:33], v4 offset:49152
  ds_read_b64_tr_b16 v[34:35], v4 offset:50176
  v_mfma_f32_16x16x32_bf16 v[68:71], v[236:239], v[48:51], v[68:71]
  ds_read_b64_tr_b16 v[36:37], v5 offset:49152
  ds_read_b64_tr_b16 v[38:39], v5 offset:50176
  v_mfma_f32_16x16x32_bf16 v[72:75], v[232:235], v[52:55], v[72:75]
  ds_read_b64_tr_b16 v[40:41], v6 offset:49152
  ds_read_b64_tr_b16 v[42:43], v6 offset:50176
  v_mfma_f32_16x16x32_bf16 v[76:79], v[236:239], v[52:55], v[76:79]
  ds_read_b64_tr_b16 v[44:45], v7 offset:49152
  ds_read_b64_tr_b16 v[46:47], v7 offset:50176
  v_mfma_f32_16x16x32_bf16 v[80:83], v[232:235], v[56:59], v[80:83]
  s_add_u32 s44, s49, 3072
  s_sub_u32 s47, s44, 14336
  v_mfma_f32_16x16x32_bf16 v[84:87], v[236:239], v[56:59], v[84:87]
  s_cselect_b32 s44, s44, s47
  buffer_load_dwordx4 v[152:155], v3, s[24:27], s44 offen
  v_mfma_f32_16x16x32_bf16 v[88:91], v[232:235], v[60:63], v[88:91]
  buffer_load_dwordx4 v[156:159], v12, s[24:27], s44 offen
  v_mfma_f32_16x16x32_bf16 v[92:95], v[236:239], v[60:63], v[92:95]
  s_waitcnt lgkmcnt(8)
  v_mfma_f32_16x16x32_bf16 v[96:99], v[232:235], v[16:19], v[96:99]
  ds_read_b64_tr_b16 v[48:49], v8 offset:49152
  ds_read_b64_tr_b16 v[50:51], v8 offset:50176
  v_mfma_f32_16x16x32_bf16 v[100:103], v[236:239], v[16:19], v[100:103]
  ds_read_b64_tr_b16 v[52:53], v9 offset:49152
  ds_read_b64_tr_b16 v[54:55], v9 offset:50176
  v_mfma_f32_16x16x32_bf16 v[104:107], v[232:235], v[20:23], v[104:107]
  ds_read_b64_tr_b16 v[56:57], v10 offset:49152
  ds_read_b64_tr_b16 v[58:59], v10 offset:50176
  v_mfma_f32_16x16x32_bf16 v[108:111], v[236:239], v[20:23], v[108:111]
  ds_read_b64_tr_b16 v[60:61], v11 offset:49152
  ds_read_b64_tr_b16 v[62:63], v11 offset:50176
  v_mfma_f32_16x16x32_bf16 v[112:115], v[232:235], v[24:27], v[112:115]
  v_mfma_f32_16x16x32_bf16 v[116:119], v[236:239], v[24:27], v[116:119]
  v_mfma_f32_16x16x32_bf16 v[120:123], v[232:235], v[28:31], v[120:123]
  v_mfma_f32_16x16x32_bf16 v[124:127], v[236:239], v[28:31], v[124:127]
  s_waitcnt vmcnt(6)
  s_waitcnt lgkmcnt(8)
  v_mfma_f32_16x16x32_bf16 v[64:67], v[240:243], v[32:35], v[64:67]
  ds_read_b64_tr_b16 v[16:17], v4 offset:57344
  ds_read_b64_tr_b16 v[18:19], v4 offset:58368
  v_mfma_f32_16x16x32_bf16 v[68:71], v[244:247], v[32:35], v[68:71]
  ds_read_b64_tr_b16 v[20:21], v5 offset:57344
  ds_read_b64_tr_b16 v[22:23], v5 offset:58368
  v_mfma_f32_16x16x32_bf16 v[72:75], v[240:243], v[36:39], v[72:75]
  ds_read_b64_tr_b16 v[24:25], v6 offset:57344
  ds_read_b64_tr_b16 v[26:27], v6 offset:58368
  v_mfma_f32_16x16x32_bf16 v[76:79], v[244:247], v[36:39], v[76:79]
  ds_read_b64_tr_b16 v[28:29], v7 offset:57344
  ds_read_b64_tr_b16 v[30:31], v7 offset:58368
  v_mfma_f32_16x16x32_bf16 v[80:83], v[240:243], v[40:43], v[80:83]
  s_add_u32 s44, s49, 4096
  s_sub_u32 s47, s44, 14336
  v_mfma_f32_16x16x32_bf16 v[84:87], v[244:247], v[40:43], v[84:87]
  s_cselect_b32 s44, s44, s47
  buffer_load_dwordx4 v[160:163], v3, s[24:27], s44 offen
  v_mfma_f32_16x16x32_bf16 v[88:91], v[240:243], v[44:47], v[88:91]
  buffer_load_dwordx4 v[164:167], v12, s[24:27], s44 offen
  v_mfma_f32_16x16x32_bf16 v[92:95], v[244:247], v[44:47], v[92:95]
  s_waitcnt lgkmcnt(8)
  v_mfma_f32_16x16x32_bf16 v[96:99], v[240:243], v[48:51], v[96:99]
  ds_read_b64_tr_b16 v[32:33], v8 offset:57344
  ds_read_b64_tr_b16 v[34:35], v8 offset:58368
  v_mfma_f32_16x16x32_bf16 v[100:103], v[244:247], v[48:51], v[100:103]
  ds_read_b64_tr_b16 v[36:37], v9 offset:57344
  ds_read_b64_tr_b16 v[38:39], v9 offset:58368
  v_mfma_f32_16x16x32_bf16 v[104:107], v[240:243], v[52:55], v[104:107]
  ds_read_b64_tr_b16 v[40:41], v10 offset:57344
  ds_read_b64_tr_b16 v[42:43], v10 offset:58368
  v_mfma_f32_16x16x32_bf16 v[108:111], v[244:247], v[52:55], v[108:111]
  ds_read_b64_tr_b16 v[44:45], v11 offset:57344
  ds_read_b64_tr_b16 v[46:47], v11 offset:58368
  v_mfma_f32_16x16x32_bf16 v[112:115], v[240:243], v[56:59], v[112:115]
  v_mfma_f32_16x16x32_bf16 v[116:119], v[244:247], v[56:59], v[116:119]
  v_mfma_f32_16x16x32_bf16 v[120:123], v[240:243], v[60:63], v[120:123]
  v_mfma_f32_16x16x32_bf16 v[124:127], v[244:247], v[60:63], v[124:127]
  s_waitcnt vmcnt(4)
  s_waitcnt lgkmcnt(8)
  v_mfma_f32_16x16x32_bf16 v[64:67], v[248:251], v[16:19], v[64:67]
  s_add_u32 s44, s49, 8192
  s_sub_u32 s47, s44, 14336
  v_mfma_f32_16x16x32_bf16 v[68:71], v[252:255], v[16:19], v[68:71]
  s_cselect_b32 s44, s44, s47
  buffer_load_dwordx4 v[192:195], v3, s[24:27], s44 offen
  v_mfma_f32_16x16x32_bf16 v[72:75], v[248:251], v[20:23], v[72:75]
  buffer_load_dwordx4 v[196:199], v12, s[24:27], s44 offen
  v_mfma_f32_16x16x32_bf16 v[76:79], v[252:255], v[20:23], v[76:79]
  v_mfma_f32_16x16x32_bf16 v[80:83], v[248:251], v[24:27], v[80:83]
  v_mfma_f32_16x16x32_bf16 v[84:87], v[252:255], v[24:27], v[84:87]
  v_mfma_f32_16x16x32_bf16 v[88:91], v[248:251], v[28:31], v[88:91]
  v_mfma_f32_16x16x32_bf16 v[92:95], v[252:255], v[28:31], v[92:95]
  s_waitcnt lgkmcnt(0)
  v_mfma_f32_16x16x32_bf16 v[96:99], v[248:251], v[32:35], v[96:99]
  ds_read_b128 v[48:51], v13 offset:16
  ds_read_b128 v[52:55], v13 offset:528
  v_mfma_f32_16x16x32_bf16 v[100:103], v[252:255], v[32:35], v[100:103]
  ds_read_b128 v[56:59], v13 offset:1040
  ds_read_b128 v[60:63], v13 offset:1552
  v_mfma_f32_16x16x32_bf16 v[104:107], v[248:251], v[36:39], v[104:107]
  v_mfma_f32_16x16x32_bf16 v[108:111], v[252:255], v[36:39], v[108:111]
  v_mfma_f32_16x16x32_bf16 v[112:115], v[248:251], v[40:43], v[112:115]
  v_mfma_f32_16x16x32_bf16 v[116:119], v[252:255], v[40:43], v[116:119]
  v_mfma_f32_16x16x32_bf16 v[120:123], v[248:251], v[44:47], v[120:123]
  v_mfma_f32_16x16x32_bf16 v[124:127], v[252:255], v[44:47], v[124:127]
  s_setprio 0
  s_add_u32 s44, s49, 9216
  s_sub_u32 s47, s44, 14336
  s_cselect_b32 s44, s44, s47
  buffer_load_dwordx4 v[200:203], v3, s[24:27], s44 offen
  buffer_load_dwordx4 v[204:207], v12, s[24:27], s44 offen
  s_add_u32 s44, s49, 10240
  s_sub_u32 s47, s44, 14336
  s_cselect_b32 s44, s44, s47
  buffer_load_dwordx4 v[208:211], v3, s[24:27], s44 offen
  buffer_load_dwordx4 v[212:215], v12, s[24:27], s44 offen
  s_add_u32 s44, s49, 11264
  s_sub_u32 s47, s44, 14336
  s_cselect_b32 s44, s44, s47
  buffer_load_dwordx4 v[216:219], v3, s[24:27], s44 offen
  buffer_load_dwordx4 v[220:223], v12, s[24:27], s44 offen
  ds_read_b128 v[240:243], v13 offset:2064
  ds_read_b128 v[244:247], v13 offset:2576
  ds_read_b128 v[248:251], v13 offset:3088
  ds_read_b128 v[252:255], v13 offset:3600
  s_waitcnt lgkmcnt(4)
  v_pk_mul_f32 v[16:17], v[64:65], v[64:65] op_sel:[0,0] op_sel_hi:[1,1]
  v_pk_mul_f32 v[18:19], v[66:67], v[66:67] op_sel:[0,0] op_sel_hi:[1,1]
  v_pk_mul_f32 v[20:21], v[72:73], v[72:73] op_sel:[0,0] op_sel_hi:[1,1]
  v_pk_mul_f32 v[22:23], v[74:75], v[74:75] op_sel:[0,0] op_sel_hi:[1,1]
  v_pk_fma_f32 v[16:17], v[48:49], v[16:17], v[48:49] op_sel:[1,0,0] op_sel_hi:[1,1,0]
  v_pk_fma_f32 v[18:19], v[48:49], v[18:19], v[48:49] op_sel:[1,0,0] op_sel_hi:[1,1,0]
  v_pk_fma_f32 v[20:21], v[52:53], v[20:21], v[52:53] op_sel:[1,0,0] op_sel_hi:[1,1,0]
  v_pk_fma_f32 v[22:23], v[52:53], v[22:23], v[52:53] op_sel:[1,0,0] op_sel_hi:[1,1,0]
  v_pk_mul_f32 v[16:17], v[16:17], v[64:65] op_sel:[0,0] op_sel_hi:[1,1]
  v_pk_mul_f32 v[18:19], v[18:19], v[66:67] op_sel:[0,0] op_sel_hi:[1,1]
  v_pk_mul_f32 v[20:21], v[20:21], v[72:73] op_sel:[0,0] op_sel_hi:[1,1]
  v_pk_mul_f32 v[22:23], v[22:23], v[74:75] op_sel:[0,0] op_sel_hi:[1,1]
  v_exp_f32 v16, v16
  v_exp_f32 v17, v17
  v_pk_mul_f32 v[64:65], v[64:65], v[68:69] op_sel:[0,0] op_sel_hi:[1,1]
  v_exp_f32 v18, v18
  v_exp_f32 v19, v19
  v_pk_mul_f32 v[66:67], v[66:67], v[70:71] op_sel:[0,0] op_sel_hi:[1,1]
  v_exp_f32 v20, v20
  v_exp_f32 v21, v21
  v_pk_mul_f32 v[72:73], v[72:73], v[76:77] op_sel:[0,0] op_sel_hi:[1,1]
  v_exp_f32 v22, v22
  v_exp_f32 v23, v23
  v_pk_mul_f32 v[74:75], v[74:75], v[78:79] op_sel:[0,0] op_sel_hi:[1,1]
  v_pk_fma_f32 v[16:17], v[16:17], v[50:51], v[50:51] op_sel:[0,0,0] op_sel_hi:[1,0,0]
  v_pk_fma_f32 v[18:19], v[18:19], v[50:51], v[50:51] op_sel:[0,0,0] op_sel_hi:[1,0,0]
  v_pk_fma_f32 v[20:21], v[20:21], v[54:55], v[54:55] op_sel:[0,0,0] op_sel_hi:[1,0,0]
  v_pk_fma_f32 v[22:23], v[22:23], v[54:55], v[54:55] op_sel:[0,0,0] op_sel_hi:[1,0,0]
  v_rcp_f32 v16, v16
  v_rcp_f32 v17, v17
  v_rcp_f32 v18, v18
  v_rcp_f32 v19, v19
  v_rcp_f32 v20, v20
  v_rcp_f32 v21, v21
  v_rcp_f32 v22, v22
  v_rcp_f32 v23, v23
  v_pk_mul_f32 v[64:65], v[64:65], v[16:17] op_sel:[0,0] op_sel_hi:[1,1]
  v_pk_mul_f32 v[66:67], v[66:67], v[18:19] op_sel:[0,0] op_sel_hi:[1,1]
  v_pk_mul_f32 v[72:73], v[72:73], v[20:21] op_sel:[0,0] op_sel_hi:[1,1]
  v_pk_mul_f32 v[74:75], v[74:75], v[22:23] op_sel:[0,0] op_sel_hi:[1,1]
  v_cvt_pk_bf16_f32 v24, v64, v65
  v_cvt_pk_bf16_f32 v25, v66, v67
  v_cvt_pk_bf16_f32 v26, v72, v73
  v_cvt_pk_bf16_f32 v27, v74, v75
  s_nop 0
  v_permlane16_swap_b32 v24, v26
  v_permlane16_swap_b32 v25, v27
  global_store_dwordx4 v2, v[24:27], s[14:15] sc1
  s_add_u32 s14, s14, 114688
  s_addc_u32 s15, s15, 0
  v_pk_mul_f32 v[32:33], v[80:81], v[80:81] op_sel:[0,0] op_sel_hi:[1,1]
  v_pk_mul_f32 v[34:35], v[82:83], v[82:83] op_sel:[0,0] op_sel_hi:[1,1]
  v_pk_mul_f32 v[36:37], v[88:89], v[88:89] op_sel:[0,0] op_sel_hi:[1,1]
  v_pk_mul_f32 v[38:39], v[90:91], v[90:91] op_sel:[0,0] op_sel_hi:[1,1]
  v_pk_fma_f32 v[32:33], v[56:57], v[32:33], v[56:57] op_sel:[1,0,0] op_sel_hi:[1,1,0]
  v_pk_fma_f32 v[34:35], v[56:57], v[34:35], v[56:57] op_sel:[1,0,0] op_sel_hi:[1,1,0]
  v_pk_fma_f32 v[36:37], v[60:61], v[36:37], v[60:61] op_sel:[1,0,0] op_sel_hi:[1,1,0]
  v_pk_fma_f32 v[38:39], v[60:61], v[38:39], v[60:61] op_sel:[1,0,0] op_sel_hi:[1,1,0]
  v_pk_mul_f32 v[32:33], v[32:33], v[80:81] op_sel:[0,0] op_sel_hi:[1,1]
  v_pk_mul_f32 v[34:35], v[34:35], v[82:83] op_sel:[0,0] op_sel_hi:[1,1]
  v_pk_mul_f32 v[36:37], v[36:37], v[88:89] op_sel:[0,0] op_sel_hi:[1,1]
  v_pk_mul_f32 v[38:39], v[38:39], v[90:91] op_sel:[0,0] op_sel_hi:[1,1]
  v_exp_f32 v32, v32
  v_exp_f32 v33, v33
  v_pk_mul_f32 v[80:81], v[80:81], v[84:85] op_sel:[0,0] op_sel_hi:[1,1]
  v_exp_f32 v34, v34
  v_exp_f32 v35, v35
  v_pk_mul_f32 v[82:83], v[82:83], v[86:87] op_sel:[0,0] op_sel_hi:[1,1]
  v_exp_f32 v36, v36
  v_exp_f32 v37, v37
  v_pk_mul_f32 v[88:89], v[88:89], v[92:93] op_sel:[0,0] op_sel_hi:[1,1]
  v_exp_f32 v38, v38
  v_exp_f32 v39, v39
  v_pk_mul_f32 v[90:91], v[90:91], v[94:95] op_sel:[0,0] op_sel_hi:[1,1]
  v_pk_fma_f32 v[32:33], v[32:33], v[58:59], v[58:59] op_sel:[0,0,0] op_sel_hi:[1,0,0]
  v_pk_fma_f32 v[34:35], v[34:35], v[58:59], v[58:59] op_sel:[0,0,0] op_sel_hi:[1,0,0]
  v_pk_fma_f32 v[36:37], v[36:37], v[62:63], v[62:63] op_sel:[0,0,0] op_sel_hi:[1,0,0]
  v_pk_fma_f32 v[38:39], v[38:39], v[62:63], v[62:63] op_sel:[0,0,0] op_sel_hi:[1,0,0]
  v_rcp_f32 v32, v32
  v_rcp_f32 v33, v33
  v_rcp_f32 v34, v34
  v_rcp_f32 v35, v35
  v_rcp_f32 v36, v36
  v_rcp_f32 v37, v37
  v_rcp_f32 v38, v38
  v_rcp_f32 v39, v39
  v_pk_mul_f32 v[80:81], v[80:81], v[32:33] op_sel:[0,0] op_sel_hi:[1,1]
  v_pk_mul_f32 v[82:83], v[82:83], v[34:35] op_sel:[0,0] op_sel_hi:[1,1]
  v_pk_mul_f32 v[88:89], v[88:89], v[36:37] op_sel:[0,0] op_sel_hi:[1,1]
  v_pk_mul_f32 v[90:91], v[90:91], v[38:39] op_sel:[0,0] op_sel_hi:[1,1]
  v_cvt_pk_bf16_f32 v40, v80, v81
  v_cvt_pk_bf16_f32 v41, v82, v83
  v_cvt_pk_bf16_f32 v42, v88, v89
  v_cvt_pk_bf16_f32 v43, v90, v91
  s_nop 0
  v_permlane16_swap_b32 v40, v42
  v_permlane16_swap_b32 v41, v43
  global_store_dwordx4 v2, v[40:43], s[14:15] sc1
  s_add_u32 s14, s14, 114688
  s_addc_u32 s15, s15, 0
  s_waitcnt lgkmcnt(0)
  v_pk_mul_f32 v[16:17], v[96:97], v[96:97] op_sel:[0,0] op_sel_hi:[1,1]
  v_pk_mul_f32 v[18:19], v[98:99], v[98:99] op_sel:[0,0] op_sel_hi:[1,1]
  v_pk_mul_f32 v[20:21], v[104:105], v[104:105] op_sel:[0,0] op_sel_hi:[1,1]
  v_pk_mul_f32 v[22:23], v[106:107], v[106:107] op_sel:[0,0] op_sel_hi:[1,1]
  v_pk_fma_f32 v[16:17], v[240:241], v[16:17], v[240:241] op_sel:[1,0,0] op_sel_hi:[1,1,0]
  v_pk_fma_f32 v[18:19], v[240:241], v[18:19], v[240:241] op_sel:[1,0,0] op_sel_hi:[1,1,0]
  v_pk_fma_f32 v[20:21], v[244:245], v[20:21], v[244:245] op_sel:[1,0,0] op_sel_hi:[1,1,0]
  v_pk_fma_f32 v[22:23], v[244:245], v[22:23], v[244:245] op_sel:[1,0,0] op_sel_hi:[1,1,0]
  v_pk_mul_f32 v[16:17], v[16:17], v[96:97] op_sel:[0,0] op_sel_hi:[1,1]
  v_pk_mul_f32 v[18:19], v[18:19], v[98:99] op_sel:[0,0] op_sel_hi:[1,1]
  v_pk_mul_f32 v[20:21], v[20:21], v[104:105] op_sel:[0,0] op_sel_hi:[1,1]
  v_pk_mul_f32 v[22:23], v[22:23], v[106:107] op_sel:[0,0] op_sel_hi:[1,1]
  v_exp_f32 v16, v16
  v_exp_f32 v17, v17
  v_pk_mul_f32 v[96:97], v[96:97], v[100:101] op_sel:[0,0] op_sel_hi:[1,1]
  v_exp_f32 v18, v18
  v_exp_f32 v19, v19
  v_pk_mul_f32 v[98:99], v[98:99], v[102:103] op_sel:[0,0] op_sel_hi:[1,1]
  v_exp_f32 v20, v20
  v_exp_f32 v21, v21
  v_pk_mul_f32 v[104:105], v[104:105], v[108:109] op_sel:[0,0] op_sel_hi:[1,1]
  v_exp_f32 v22, v22
  v_exp_f32 v23, v23
  v_pk_mul_f32 v[106:107], v[106:107], v[110:111] op_sel:[0,0] op_sel_hi:[1,1]
  v_pk_fma_f32 v[16:17], v[16:17], v[242:243], v[242:243] op_sel:[0,0,0] op_sel_hi:[1,0,0]
  v_pk_fma_f32 v[18:19], v[18:19], v[242:243], v[242:243] op_sel:[0,0,0] op_sel_hi:[1,0,0]
  v_pk_fma_f32 v[20:21], v[20:21], v[246:247], v[246:247] op_sel:[0,0,0] op_sel_hi:[1,0,0]
  v_pk_fma_f32 v[22:23], v[22:23], v[246:247], v[246:247] op_sel:[0,0,0] op_sel_hi:[1,0,0]
  v_rcp_f32 v16, v16
  v_rcp_f32 v17, v17
  v_rcp_f32 v18, v18
  v_rcp_f32 v19, v19
  v_rcp_f32 v20, v20
  v_rcp_f32 v21, v21
  v_rcp_f32 v22, v22
  v_rcp_f32 v23, v23
  v_pk_mul_f32 v[96:97], v[96:97], v[16:17] op_sel:[0,0] op_sel_hi:[1,1]
  v_pk_mul_f32 v[98:99], v[98:99], v[18:19] op_sel:[0,0] op_sel_hi:[1,1]
  v_pk_mul_f32 v[104:105], v[104:105], v[20:21] op_sel:[0,0] op_sel_hi:[1,1]
  v_pk_mul_f32 v[106:107], v[106:107], v[22:23] op_sel:[0,0] op_sel_hi:[1,1]
  v_cvt_pk_bf16_f32 v24, v96, v97
  v_cvt_pk_bf16_f32 v25, v98, v99
  v_cvt_pk_bf16_f32 v26, v104, v105
  v_cvt_pk_bf16_f32 v27, v106, v107
  s_nop 0
  v_permlane16_swap_b32 v24, v26
  v_permlane16_swap_b32 v25, v27
  global_store_dwordx4 v2, v[24:27], s[14:15] sc1
  s_add_u32 s14, s14, 114688
  s_addc_u32 s15, s15, 0
  v_pk_mul_f32 v[32:33], v[112:113], v[112:113] op_sel:[0,0] op_sel_hi:[1,1]
  v_pk_mul_f32 v[34:35], v[114:115], v[114:115] op_sel:[0,0] op_sel_hi:[1,1]
  v_pk_mul_f32 v[36:37], v[120:121], v[120:121] op_sel:[0,0] op_sel_hi:[1,1]
  v_pk_mul_f32 v[38:39], v[122:123], v[122:123] op_sel:[0,0] op_sel_hi:[1,1]
  v_pk_fma_f32 v[32:33], v[248:249], v[32:33], v[248:249] op_sel:[1,0,0] op_sel_hi:[1,1,0]
  v_pk_fma_f32 v[34:35], v[248:249], v[34:35], v[248:249] op_sel:[1,0,0] op_sel_hi:[1,1,0]
  v_pk_fma_f32 v[36:37], v[252:253], v[36:37], v[252:253] op_sel:[1,0,0] op_sel_hi:[1,1,0]
  v_pk_fma_f32 v[38:39], v[252:253], v[38:39], v[252:253] op_sel:[1,0,0] op_sel_hi:[1,1,0]
  v_pk_mul_f32 v[32:33], v[32:33], v[112:113] op_sel:[0,0] op_sel_hi:[1,1]
  v_pk_mul_f32 v[34:35], v[34:35], v[114:115] op_sel:[0,0] op_sel_hi:[1,1]
  v_pk_mul_f32 v[36:37], v[36:37], v[120:121] op_sel:[0,0] op_sel_hi:[1,1]
  v_pk_mul_f32 v[38:39], v[38:39], v[122:123] op_sel:[0,0] op_sel_hi:[1,1]
  v_exp_f32 v32, v32
  v_exp_f32 v33, v33
  v_pk_mul_f32 v[112:113], v[112:113], v[116:117] op_sel:[0,0] op_sel_hi:[1,1]
  v_exp_f32 v34, v34
  v_exp_f32 v35, v35
  v_pk_mul_f32 v[114:115], v[114:115], v[118:119] op_sel:[0,0] op_sel_hi:[1,1]
  v_exp_f32 v36, v36
  v_exp_f32 v37, v37
  v_pk_mul_f32 v[120:121], v[120:121], v[124:125] op_sel:[0,0] op_sel_hi:[1,1]
  v_exp_f32 v38, v38
  v_exp_f32 v39, v39
  v_pk_mul_f32 v[122:123], v[122:123], v[126:127] op_sel:[0,0] op_sel_hi:[1,1]
  v_pk_fma_f32 v[32:33], v[32:33], v[250:251], v[250:251] op_sel:[0,0,0] op_sel_hi:[1,0,0]
  v_pk_fma_f32 v[34:35], v[34:35], v[250:251], v[250:251] op_sel:[0,0,0] op_sel_hi:[1,0,0]
  v_pk_fma_f32 v[36:37], v[36:37], v[254:255], v[254:255] op_sel:[0,0,0] op_sel_hi:[1,0,0]
  v_pk_fma_f32 v[38:39], v[38:39], v[254:255], v[254:255] op_sel:[0,0,0] op_sel_hi:[1,0,0]
  v_rcp_f32 v32, v32
  v_rcp_f32 v33, v33
  v_rcp_f32 v34, v34
  v_rcp_f32 v35, v35
  v_rcp_f32 v36, v36
  v_rcp_f32 v37, v37
  v_rcp_f32 v38, v38
  v_rcp_f32 v39, v39
  v_pk_mul_f32 v[112:113], v[112:113], v[32:33] op_sel:[0,0] op_sel_hi:[1,1]
  v_pk_mul_f32 v[114:115], v[114:115], v[34:35] op_sel:[0,0] op_sel_hi:[1,1]
  v_pk_mul_f32 v[120:121], v[120:121], v[36:37] op_sel:[0,0] op_sel_hi:[1,1]
  v_pk_mul_f32 v[122:123], v[122:123], v[38:39] op_sel:[0,0] op_sel_hi:[1,1]
  v_cvt_pk_bf16_f32 v40, v112, v113
  v_cvt_pk_bf16_f32 v41, v114, v115
  v_cvt_pk_bf16_f32 v42, v120, v121
  v_cvt_pk_bf16_f32 v43, v122, v123
  s_nop 0
  v_permlane16_swap_b32 v40, v42
  v_permlane16_swap_b32 v41, v43
  global_store_dwordx4 v2, v[40:43], s[14:15] sc1
  s_add_u32 s44, s49, 12288
  s_sub_u32 s47, s44, 14336
  s_cselect_b32 s44, s44, s47
  buffer_load_dwordx4 v[224:227], v3, s[24:27], s44 offen
  buffer_load_dwordx4 v[228:231], v12, s[24:27], s44 offen
  s_add_u32 s44, s49, 13312
  s_sub_u32 s47, s44, 14336
  s_cselect_b32 s44, s44, s47
  buffer_load_dwordx4 v[232:235], v3, s[24:27], s44 offen
  buffer_load_dwordx4 v[236:239], v12, s[24:27], s44 offen
K2_P2:
  s_lshl_b32 s45, s37, 6
  s_lshl_b32 s12, s39, 5
  s_add_u32 s45, s45, s12
  s_lshl_b32 s12, s43, 4
  s_add_u32 s45, s45, s12
  s_lshl_b32 s46, s38, 6
  s_lshl_b32 s12, s42, 5
  s_add_u32 s46, s46, s12
  v_lshrrev_b32 v6, 5, v1
  v_and_b32 v7, 31, v1
  s_lshl_b32 s12, s45, 2
  s_add_u32 s12, s12, 10240
  s_add_u32 s14, s4, s12
  s_addc_u32 s15, s5, 0
  s_add_u32 s28, s14, 12288
  s_addc_u32 s29, s15, 0
  v_lshlrev_b32 v8, 4, v6
  global_load_dwordx4 v[248:251], v8, s[14:15]
  global_load_dwordx4 v[252:255], v8, s[14:15] offset:32
  global_load_dwordx4 v[56:59], v8, s[28:29]
  global_load_dwordx4 v[60:63], v8, s[28:29] offset:32
  v_add_lshl_u32 v9, v7, s46, 1
  v_lshl_add_u32 v9, v6, 10, v9
  s_sub_u32 s12, s37, s48
  s_and_b32 s12, s12, 7
  s_lshl_b32 s12, s12, 6
  s_and_b32 s13, s45, 63
  s_add_u32 s12, s12, s13
  s_lshl_b32 s12, s12, 8
  v_add_u32 v9, s12, v9
  v_xor_b32 v10, 0, v9
  ds_read_u16 v240, v10 offset:0
  v_xor_b32 v11, 64, v9
  ds_read_u16 v241, v11 offset:256
  v_xor_b32 v10, 128, v9
  ds_read_u16 v242, v10 offset:512
  v_xor_b32 v11, 192, v9
  ds_read_u16 v243, v11 offset:768
  v_xor_b32 v10, 32, v9
  ds_read_u16 v244, v10 offset:2048
  v_xor_b32 v11, 96, v9
  ds_read_u16 v245, v11 offset:2304
  v_xor_b32 v10, 160, v9
  ds_read_u16 v246, v10 offset:2560
  v_xor_b32 v11, 224, v9
  ds_read_u16 v247, v11 offset:2816
  s_lshl_b32 s12, s8, 7
  s_add_u32 s12, s12, s46
  s_lshl_b32 s12, s12, 10
  s_lshl_b32 s13, s45, 1
  s_add_u32 s12, s12, s13
  s_add_u32 s50, s50, s12
  s_addc_u32 s51, s51, 0
  v_lshl_add_u32 v15, v7, 10, v8
  s_lshl_b32 s12, s8, 1
  s_add_u32 s12, s12, s38
  s_mul_i32 s12, s12, 229376
  s_mul_i32 s13, s33, 14336
  s_add_u32 s12, s12, s13
  s_add_u32 s12, s12, 0x1200000
  s_add_u32 s20, s4, s12
  s_addc_u32 s21, s5, 0
  s_mov_b32 s22, 129024
  s_mov_b32 s23, 0x20000
  s_mul_i32 s12, s42, 114688
  v_add_u32 v13, s12, v2
  s_sub_u32 s12, 114688, s12
  v_add_u32 v14, s12, v2
  s_waitcnt vmcnt(8) lgkmcnt(0)
  s_lshl_b32 s12, s8, 11
  s_add_u32 s12, s12, 0x48000
  s_add_u32 s28, s4, s12
  s_addc_u32 s29, s5, 0
  s_lshl_b32 s12, s30, 7
  v_mov_b32 v4, s12
  v_mov_b32 v5, 1
  s_cmp_lg_u32 s33, 3
  s_barrier
  s_cbranch_scc1 K2_NS
  global_store_dword v4, v5, s[28:29] sc1
K2_NS:
  s_cmp_lg_u32 s33, 7
  s_cbranch_scc1 K2_GO2
  s_sleep 13
  v_and_b32 v4, 15, v1
  v_lshlrev_b32 v4, 7, v4
  s_mov_b32 s36, 131072
K2_POLL2:
  global_load_dword v16, v4, s[28:29] sc1
  s_waitcnt vmcnt(0)
  v_cmp_ne_u32 vcc, 1, v16
  s_nop 1
  s_cmp_eq_u64 vcc, 0
  s_cbranch_scc1 K2_GO2
  s_sleep 1
  s_sub_u32 s36, s36, 1
  s_cmp_lg_u32 s36, 0
  s_cbranch_scc1 K2_POLL2
K2_GO2:
  s_barrier
  s_add_u32 s44, s49, 0
  s_sub_u32 s47, s44, 14336
  s_cselect_b32 s44, s44, s47
  buffer_load_dwordx4 v[16:19], v13, s[20:23], s44 offen sc1
  buffer_load_dwordx4 v[20:23], v14, s[20:23], s44 offen sc1
  s_add_u32 s44, s49, 1024
  s_sub_u32 s47, s44, 14336
  s_cselect_b32 s44, s44, s47
  buffer_load_dwordx4 v[24:27], v13, s[20:23], s44 offen sc1
  buffer_load_dwordx4 v[28:31], v14, s[20:23], s44 offen sc1
  s_add_u32 s44, s49, 2048
  s_sub_u32 s47, s44, 14336
  s_cselect_b32 s44, s44, s47
  buffer_load_dwordx4 v[32:35], v13, s[20:23], s44 offen sc1
  buffer_load_dwordx4 v[36:39], v14, s[20:23], s44 offen sc1
  s_add_u32 s44, s49, 3072
  s_sub_u32 s47, s44, 14336
  s_cselect_b32 s44, s44, s47
  buffer_load_dwordx4 v[40:43], v13, s[20:23], s44 offen sc1
  buffer_load_dwordx4 v[44:47], v14, s[20:23], s44 offen sc1
  s_add_u32 s44, s49, 4096
  s_sub_u32 s47, s44, 14336
  s_cselect_b32 s44, s44, s47
  buffer_load_dwordx4 v[48:51], v13, s[20:23], s44 offen sc1
  buffer_load_dwordx4 v[52:55], v14, s[20:23], s44 offen sc1
  s_waitcnt vmcnt(10)
  v_pk_add_f32 v[248:249], v[248:249], v[56:57] op_sel:[0,0] op_sel_hi:[1,1]
  v_pk_add_f32 v[250:251], v[250:251], v[58:59] op_sel:[0,0] op_sel_hi:[1,1]
  v_pk_add_f32 v[252:253], v[252:253], v[60:61] op_sel:[0,0] op_sel_hi:[1,1]
  v_pk_add_f32 v[254:255], v[254:255], v[62:63] op_sel:[0,0] op_sel_hi:[1,1]
  s_add_u32 s44, s49, 5120
  s_sub_u32 s47, s44, 14336
  s_cselect_b32 s44, s44, s47
  buffer_load_dwordx4 v[56:59], v13, s[20:23], s44 offen sc1
  buffer_load_dwordx4 v[60:63], v14, s[20:23], s44 offen sc1
  v_cvt_pk_bf16_f32 v4, v248, v249
  v_lshlrev_b32 v248, 16, v4
  v_and_b32 v249, 0xffff0000, v4
  v_cvt_pk_bf16_f32 v4, v250, v251
  v_lshlrev_b32 v250, 16, v4
  v_and_b32 v251, 0xffff0000, v4
  v_cvt_pk_bf16_f32 v4, v252, v253
  v_lshlrev_b32 v252, 16, v4
  v_and_b32 v253, 0xffff0000, v4
  v_cvt_pk_bf16_f32 v4, v254, v255
  v_lshlrev_b32 v254, 16, v4
  v_and_b32 v255, 0xffff0000, v4
  s_xor_b32 s12, s33, 1
  s_mul_i32 s12, s12, 14336
  s_add_u32 s12, s12, 0
  v_add_u32 v4, s12, v2
  s_xor_b32 s12, s33, 2
  s_mul_i32 s12, s12, 14336
  s_add_u32 s12, s12, 2048
  v_add_u32 v5, s12, v2
  s_xor_b32 s12, s33, 3
  s_mul_i32 s12, s12, 14336
  s_add_u32 s12, s12, 4096
  v_add_u32 v6, s12, v2
  s_xor_b32 s12, s33, 4
  s_mul_i32 s12, s12, 14336
  s_add_u32 s12, s12, 6144
  v_add_u32 v7, s12, v2
  s_xor_b32 s12, s33, 5
  s_mul_i32 s12, s12, 14336
  s_add_u32 s12, s12, 8192
  v_add_u32 v8, s12, v2
  s_xor_b32 s12, s33, 6
  s_mul_i32 s12, s12, 14336
  s_add_u32 s12, s12, 10240
  v_add_u32 v9, s12, v2
  s_xor_b32 s12, s33, 7
  s_mul_i32 s12, s12, 14336
  s_add_u32 s12, s12, 12288
  v_add_u32 v10, s12, v2
  s_mul_i32 s12, s33, 14336
  v_add_u32 v3, s12, v2
  v_lshlrev_b32 v240, 16, v240
  v_lshlrev_b32 v241, 16, v241
  v_lshlrev_b32 v242, 16, v242
  v_lshlrev_b32 v243, 16, v243
  v_lshlrev_b32 v244, 16, v244
  v_lshlrev_b32 v245, 16, v245
  v_lshlrev_b32 v246, 16, v246
  v_lshlrev_b32 v247, 16, v247
  s_waitcnt vmcnt(10)
  v_mfma_f32_32x32x16_bf16 v[64:79], v[128:131], v[16:19], 0
  v_mfma_f32_32x32x16_bf16 v[80:95], v[132:135], v[16:19], 0
  v_mfma_f32_32x32x16_bf16 v[96:111], v[128:131], v[20:23], 0
  v_mfma_f32_32x32x16_bf16 v[112:127], v[132:135], v[20:23], 0
  s_add_u32 s44, s49, 6144
  s_sub_u32 s47, s44, 14336
  s_cselect_b32 s44, s44, s47
  buffer_load_dwordx4 v[16:19], v13, s[20:23], s44 offen sc1
  buffer_load_dwordx4 v[20:23], v14, s[20:23], s44 offen sc1
  s_waitcnt vmcnt(10)
  v_mfma_f32_32x32x16_bf16 v[64:79], v[136:139], v[24:27], v[64:79]
  v_mfma_f32_32x32x16_bf16 v[80:95], v[140:143], v[24:27], v[80:95]
  v_mfma_f32_32x32x16_bf16 v[96:111], v[136:139], v[28:31], v[96:111]
  v_mfma_f32_32x32x16_bf16 v[112:127], v[140:143], v[28:31], v[112:127]
  s_add_u32 s44, s49, 7168
  s_sub_u32 s47, s44, 14336
  s_cselect_b32 s44, s44, s47
  buffer_load_dwordx4 v[24:27], v13, s[20:23], s44 offen sc1
  buffer_load_dwordx4 v[28:31], v14, s[20:23], s44 offen sc1
  s_waitcnt vmcnt(10)
  v_mfma_f32_32x32x16_bf16 v[64:79], v[144:147], v[32:35], v[64:79]
  v_mfma_f32_32x32x16_bf16 v[80:95], v[148:151], v[32:35], v[80:95]
  v_mfma_f32_32x32x16_bf16 v[96:111], v[144:147], v[36:39], v[96:111]
  v_mfma_f32_32x32x16_bf16 v[112:127], v[148:151], v[36:39], v[112:127]
  s_add_u32 s44, s49, 8192
  s_sub_u32 s47, s44, 14336
  s_cselect_b32 s44, s44, s47
  buffer_load_dwordx4 v[32:35], v13, s[20:23], s44 offen sc1
  buffer_load_dwordx4 v[36:39], v14, s[20:23], s44 offen sc1
  s_waitcnt vmcnt(10)
  v_mfma_f32_32x32x16_bf16 v[64:79], v[152:155], v[40:43], v[64:79]
  v_mfma_f32_32x32x16_bf16 v[80:95], v[156:159], v[40:43], v[80:95]
  v_mfma_f32_32x32x16_bf16 v[96:111], v[152:155], v[44:47], v[96:111]
  v_mfma_f32_32x32x16_bf16 v[112:127], v[156:159], v[44:47], v[112:127]
  s_add_u32 s44, s49, 9216
  s_sub_u32 s47, s44, 14336
  s_cselect_b32 s44, s44, s47
  buffer_load_dwordx4 v[40:43], v13, s[20:23], s44 offen sc1
  buffer_load_dwordx4 v[44:47], v14, s[20:23], s44 offen sc1
  s_waitcnt vmcnt(10)
  v_mfma_f32_32x32x16_bf16 v[64:79], v[160:163], v[48:51], v[64:79]
  v_mfma_f32_32x32x16_bf16 v[80:95], v[164:167], v[48:51], v[80:95]
  v_mfma_f32_32x32x16_bf16 v[96:111], v[160:163], v[52:55], v[96:111]
  v_mfma_f32_32x32x16_bf16 v[112:127], v[164:167], v[52:55], v[112:127]
  s_add_u32 s44, s49, 10240
  s_sub_u32 s47, s44, 14336
  s_cselect_b32 s44, s44, s47
  buffer_load_dwordx4 v[48:51], v13, s[20:23], s44 offen sc1
  buffer_load_dwordx4 v[52:55], v14, s[20:23], s44 offen sc1
  s_waitcnt vmcnt(10)
  v_mfma_f32_32x32x16_bf16 v[64:79], v[168:171], v[56:59], v[64:79]
  v_mfma_f32_32x32x16_bf16 v[80:95], v[172:175], v[56:59], v[80:95]
  v_mfma_f32_32x32x16_bf16 v[96:111], v[168:171], v[60:63], v[96:111]
  v_mfma_f32_32x32x16_bf16 v[112:127], v[172:175], v[60:63], v[112:127]
  s_add_u32 s44, s49, 11264
  s_sub_u32 s47, s44, 14336
  s_cselect_b32 s44, s44, s47
  buffer_load_dwordx4 v[56:59], v13, s[20:23], s44 offen sc1
  buffer_load_dwordx4 v[60:63], v14, s[20:23], s44 offen sc1
  s_waitcnt vmcnt(10)
  v_mfma_f32_32x32x16_bf16 v[64:79], v[176:179], v[16:19], v[64:79]
  v_mfma_f32_32x32x16_bf16 v[80:95], v[180:183], v[16:19], v[80:95]
  v_mfma_f32_32x32x16_bf16 v[96:111], v[176:179], v[20:23], v[96:111]
  v_mfma_f32_32x32x16_bf16 v[112:127], v[180:183], v[20:23], v[112:127]
  s_add_u32 s44, s49, 12288
  s_sub_u32 s47, s44, 14336
  s_cselect_b32 s44, s44, s47
  buffer_load_dwordx4 v[16:19], v13, s[20:23], s44 offen sc1
  buffer_load_dwordx4 v[20:23], v14, s[20:23], s44 offen sc1
  s_waitcnt vmcnt(10)
  v_mfma_f32_32x32x16_bf16 v[64:79], v[184:187], v[24:27], v[64:79]
  v_mfma_f32_32x32x16_bf16 v[80:95], v[188:191], v[24:27], v[80:95]
  v_mfma_f32_32x32x16_bf16 v[96:111], v[184:187], v[28:31], v[96:111]
  v_mfma_f32_32x32x16_bf16 v[112:127], v[188:191], v[28:31], v[112:127]
  s_add_u32 s44, s49, 13312
  s_sub_u32 s47, s44, 14336
  s_cselect_b32 s44, s44, s47
  buffer_load_dwordx4 v[24:27], v13, s[20:23], s44 offen sc1
  buffer_load_dwordx4 v[28:31], v14, s[20:23], s44 offen sc1
  s_waitcnt vmcnt(10)
  v_mfma_f32_32x32x16_bf16 v[64:79], v[192:195], v[32:35], v[64:79]
  v_mfma_f32_32x32x16_bf16 v[80:95], v[196:199], v[32:35], v[80:95]
  v_mfma_f32_32x32x16_bf16 v[96:111], v[192:195], v[36:39], v[96:111]
  v_mfma_f32_32x32x16_bf16 v[112:127], v[196:199], v[36:39], v[112:127]
  s_waitcnt vmcnt(8)
  v_mfma_f32_32x32x16_bf16 v[64:79], v[200:203], v[40:43], v[64:79]
  v_mfma_f32_32x32x16_bf16 v[80:95], v[204:207], v[40:43], v[80:95]
  v_mfma_f32_32x32x16_bf16 v[96:111], v[200:203], v[44:47], v[96:111]
  v_mfma_f32_32x32x16_bf16 v[112:127], v[204:207], v[44:47], v[112:127]
  s_waitcnt vmcnt(6)
  v_mfma_f32_32x32x16_bf16 v[64:79], v[208:211], v[48:51], v[64:79]
  v_mfma_f32_32x32x16_bf16 v[80:95], v[212:215], v[48:51], v[80:95]
  v_mfma_f32_32x32x16_bf16 v[96:111], v[208:211], v[52:55], v[96:111]
  v_mfma_f32_32x32x16_bf16 v[112:127], v[212:215], v[52:55], v[112:127]
  s_waitcnt vmcnt(4)
  v_mfma_f32_32x32x16_bf16 v[64:79], v[216:219], v[56:59], v[64:79]
  v_mfma_f32_32x32x16_bf16 v[80:95], v[220:223], v[56:59], v[80:95]
  v_mfma_f32_32x32x16_bf16 v[96:111], v[216:219], v[60:63], v[96:111]
  v_mfma_f32_32x32x16_bf16 v[112:127], v[220:223], v[60:63], v[112:127]
  s_waitcnt vmcnt(2)
  v_mfma_f32_32x32x16_bf16 v[64:79], v[224:227], v[16:19], v[64:79]
  v_mfma_f32_32x32x16_bf16 v[80:95], v[228:231], v[16:19], v[80:95]
  v_mfma_f32_32x32x16_bf16 v[96:111], v[224:227], v[20:23], v[96:111]
  v_mfma_f32_32x32x16_bf16 v[112:127], v[228:231], v[20:23], v[112:127]
  s_waitcnt vmcnt(0)
  v_mfma_f32_32x32x16_bf16 v[64:79], v[232:235], v[24:27], v[64:79]
  v_mfma_f32_32x32x16_bf16 v[80:95], v[236:239], v[24:27], v[80:95]
  v_mfma_f32_32x32x16_bf16 v[96:111], v[232:235], v[28:31], v[96:111]
  v_mfma_f32_32x32x16_bf16 v[112:127], v[236:239], v[28:31], v[112:127]
  s_nop 9
  ds_write_b128 v4, v[80:83]
  ds_write_b128 v4, v[84:87] offset:1024
  ds_write_b128 v5, v[96:99]
  ds_write_b128 v5, v[100:103] offset:1024
  ds_write_b128 v6, v[112:115]
  ds_write_b128 v6, v[116:119] offset:1024
  ds_write_b128 v8, v[88:91]
  ds_write_b128 v8, v[92:95] offset:1024
  ds_write_b128 v9, v[104:107]
  ds_write_b128 v9, v[108:111] offset:1024
  ds_write_b128 v10, v[120:123]
  ds_write_b128 v10, v[124:127] offset:1024
  ds_write_b128 v7, v[72:75]
  ds_write_b128 v7, v[76:79] offset:1024
  v_pk_fma_f32 v[240:241], v[64:65], v[248:249], v[240:241] op_sel:[0,0,0] op_sel_hi:[1,1,1]
  v_pk_fma_f32 v[242:243], v[66:67], v[250:251], v[242:243] op_sel:[0,0,0] op_sel_hi:[1,1,1]
  v_pk_fma_f32 v[244:245], v[68:69], v[252:253], v[244:245] op_sel:[0,0,0] op_sel_hi:[1,1,1]
  v_pk_fma_f32 v[246:247], v[70:71], v[254:255], v[246:247] op_sel:[0,0,0] op_sel_hi:[1,1,1]
  s_waitcnt lgkmcnt(0)
  s_barrier
  ds_read_b128 v[64:67], v3 offset:0
  ds_read_b128 v[68:71], v3 offset:1024
  ds_read_b128 v[72:75], v3 offset:2048
  ds_read_b128 v[76:79], v3 offset:3072
  ds_read_b128 v[80:83], v3 offset:4096
  ds_read_b128 v[84:87], v3 offset:5120
  ds_read_b128 v[88:91], v3 offset:6144
  ds_read_b128 v[92:95], v3 offset:7168
  ds_read_b128 v[96:99], v3 offset:8192
  ds_read_b128 v[100:103], v3 offset:9216
  ds_read_b128 v[104:107], v3 offset:10240
  ds_read_b128 v[108:111], v3 offset:11264
  ds_read_b128 v[112:115], v3 offset:12288
  ds_read_b128 v[116:119], v3 offset:13312
  s_waitcnt lgkmcnt(6)
  v_pk_add_f32 v[64:65], v[64:65], v[72:73] op_sel:[0,0] op_sel_hi:[1,1]
  v_pk_add_f32 v[80:81], v[80:81], v[88:89] op_sel:[0,0] op_sel_hi:[1,1]
  v_pk_add_f32 v[66:67], v[66:67], v[74:75] op_sel:[0,0] op_sel_hi:[1,1]
  v_pk_add_f32 v[82:83], v[82:83], v[90:91] op_sel:[0,0] op_sel_hi:[1,1]
  v_pk_add_f32 v[68:69], v[68:69], v[76:77] op_sel:[0,0] op_sel_hi:[1,1]
  v_pk_add_f32 v[84:85], v[84:85], v[92:93] op_sel:[0,0] op_sel_hi:[1,1]
  v_pk_add_f32 v[70:71], v[70:71], v[78:79] op_sel:[0,0] op_sel_hi:[1,1]
  v_pk_add_f32 v[86:87], v[86:87], v[94:95] op_sel:[0,0] op_sel_hi:[1,1]
  s_waitcnt lgkmcnt(2)
  v_pk_add_f32 v[64:65], v[64:65], v[80:81] op_sel:[0,0] op_sel_hi:[1,1]
  v_pk_add_f32 v[96:97], v[96:97], v[104:105] op_sel:[0,0] op_sel_hi:[1,1]
  v_pk_add_f32 v[66:67], v[66:67], v[82:83] op_sel:[0,0] op_sel_hi:[1,1]
  v_pk_add_f32 v[98:99], v[98:99], v[106:107] op_sel:[0,0] op_sel_hi:[1,1]
  v_pk_add_f32 v[68:69], v[68:69], v[84:85] op_sel:[0,0] op_sel_hi:[1,1]
  v_pk_add_f32 v[100:101], v[100:101], v[108:109] op_sel:[0,0] op_sel_hi:[1,1]
  v_pk_add_f32 v[70:71], v[70:71], v[86:87] op_sel:[0,0] op_sel_hi:[1,1]
  v_pk_add_f32 v[102:103], v[102:103], v[110:111] op_sel:[0,0] op_sel_hi:[1,1]
  s_waitcnt lgkmcnt(0)
  v_pk_add_f32 v[64:65], v[64:65], v[112:113] op_sel:[0,0] op_sel_hi:[1,1]
  v_pk_add_f32 v[66:67], v[66:67], v[114:115] op_sel:[0,0] op_sel_hi:[1,1]
  v_pk_add_f32 v[68:69], v[68:69], v[116:117] op_sel:[0,0] op_sel_hi:[1,1]
  v_pk_add_f32 v[70:71], v[70:71], v[118:119] op_sel:[0,0] op_sel_hi:[1,1]
  v_pk_add_f32 v[64:65], v[64:65], v[96:97] op_sel:[0,0] op_sel_hi:[1,1]
  v_pk_add_f32 v[66:67], v[66:67], v[98:99] op_sel:[0,0] op_sel_hi:[1,1]
  v_pk_add_f32 v[68:69], v[68:69], v[100:101] op_sel:[0,0] op_sel_hi:[1,1]
  v_pk_add_f32 v[70:71], v[70:71], v[102:103] op_sel:[0,0] op_sel_hi:[1,1]
  v_pk_fma_f32 v[240:241], v[64:65], v[248:249], v[240:241] op_sel:[0,0,0] op_sel_hi:[1,1,1]
  v_pk_fma_f32 v[242:243], v[66:67], v[250:251], v[242:243] op_sel:[0,0,0] op_sel_hi:[1,1,1]
  v_pk_fma_f32 v[244:245], v[68:69], v[252:253], v[244:245] op_sel:[0,0,0] op_sel_hi:[1,1,1]
  v_pk_fma_f32 v[246:247], v[70:71], v[254:255], v[246:247] op_sel:[0,0,0] op_sel_hi:[1,1,1]
  v_cvt_pk_bf16_f32 v64, v240, v241
  v_cvt_pk_bf16_f32 v65, v242, v243
  v_cvt_pk_bf16_f32 v66, v244, v245
  v_cvt_pk_bf16_f32 v67, v246, v247
  s_nop 0
  v_permlane32_swap_b32 v64, v66
  v_permlane32_swap_b32 v65, v67
  global_store_dwordx4 v15, v[64:67], s[50:51]
  s_endpgm
K2_AUX:
  s_add_u32 s16, s4, s10
  s_addc_u32 s17, s5, 0
  s_mov_b32 s18, 131072
  s_mov_b32 s19, 0x20000
  s_lshl_b32 s35, s48, 14
  s_add_u32 s35, s35, s34
  s_mov_b32 m0, s34
  s_nop 0
  buffer_load_dwordx4 v2, s[16:19], s35 offen lds
  buffer_load_dwordx4 v2, s[16:19], s35 offen offset:1024 lds
  s_barrier
  s_setprio 3
  s_add_u32 s35, s48, 1
  s_and_b32 s35, s35, 7
  s_lshl_b32 s35, s35, 14
  s_mov_b32 m0, 16384
  s_nop 0
  buffer_load_dwordx4 v2, s[16:19], s35 offen offset:0 lds
  buffer_load_dwordx4 v2, s[16:19], s35 offen offset:1024 lds
  buffer_load_dwordx4 v2, s[16:19], s35 offen offset:2048 lds
  buffer_load_dwordx4 v2, s[16:19], s35 offen offset:3072 lds
  s_mov_b32 m0, 20480
  s_add_u32 s35, s35, 4096
  buffer_load_dwordx4 v2, s[16:19], s35 offen offset:0 lds
  buffer_load_dwordx4 v2, s[16:19], s35 offen offset:1024 lds
  buffer_load_dwordx4 v2, s[16:19], s35 offen offset:2048 lds
  buffer_load_dwordx4 v2, s[16:19], s35 offen offset:3072 lds
  s_mov_b32 m0, 24576
  s_add_u32 s35, s35, 4096
  buffer_load_dwordx4 v2, s[16:19], s35 offen offset:0 lds
  buffer_load_dwordx4 v2, s[16:19], s35 offen offset:1024 lds
  buffer_load_dwordx4 v2, s[16:19], s35 offen offset:2048 lds
  buffer_load_dwordx4 v2, s[16:19], s35 offen offset:3072 lds
  s_mov_b32 m0, 28672
  s_add_u32 s35, s35, 4096
  buffer_load_dwordx4 v2, s[16:19], s35 offen offset:0 lds
  buffer_load_dwordx4 v2, s[16:19], s35 offen offset:1024 lds
  buffer_load_dwordx4 v2, s[16:19], s35 offen offset:2048 lds
  buffer_load_dwordx4 v2, s[16:19], s35 offen offset:3072 lds
  s_add_u32 s35, s48, 2
  s_and_b32 s35, s35, 7
  s_lshl_b32 s35, s35, 14
  s_mov_b32 m0, 32768
  s_nop 0
  buffer_load_dwordx4 v2, s[16:19], s35 offen offset:0 lds
  buffer_load_dwordx4 v2, s[16:19], s35 offen offset:1024 lds
  buffer_load_dwordx4 v2, s[16:19], s35 offen offset:2048 lds
  buffer_load_dwordx4 v2, s[16:19], s35 offen offset:3072 lds
  s_mov_b32 m0, 36864
  s_add_u32 s35, s35, 4096
  buffer_load_dwordx4 v2, s[16:19], s35 offen offset:0 lds
  buffer_load_dwordx4 v2, s[16:19], s35 offen offset:1024 lds
  buffer_load_dwordx4 v2, s[16:19], s35 offen offset:2048 lds
  buffer_load_dwordx4 v2, s[16:19], s35 offen offset:3072 lds
  s_mov_b32 m0, 40960
  s_add_u32 s35, s35, 4096
  buffer_load_dwordx4 v2, s[16:19], s35 offen offset:0 lds
  buffer_load_dwordx4 v2, s[16:19], s35 offen offset:1024 lds
  buffer_load_dwordx4 v2, s[16:19], s35 offen offset:2048 lds
  buffer_load_dwordx4 v2, s[16:19], s35 offen offset:3072 lds
  s_mov_b32 m0, 45056
  s_add_u32 s35, s35, 4096
  buffer_load_dwordx4 v2, s[16:19], s35 offen offset:0 lds
  buffer_load_dwordx4 v2, s[16:19], s35 offen offset:1024 lds
  buffer_load_dwordx4 v2, s[16:19], s35 offen offset:2048 lds
  buffer_load_dwordx4 v2, s[16:19], s35 offen offset:3072 lds
  s_lshr_b32 s12, s30, 1
  s_lshl_b32 s12, s12, 5
  v_lshrrev_b32 v20, 1, v1
  v_and_b32 v21, 3, v20
  v_lshlrev_b32 v21, 6, v21
  v_bfe_u32 v22, v20, 3, 1
  v_lshl_add_u32 v21, v22, 5, v21
  v_xor_b32 v21, s12, v21
  v_lshl_add_u32 v21, v20, 8, v21
  v_and_b32 v22, 1, v1
  v_lshl_add_u32 v21, v22, 4, v21
  s_and_b32 s13, s30, 1
  s_lshl_b32 s31, s13, 16
  s_add_u32 s14, s4, 0x11000
  s_addc_u32 s15, s5, 0
  v_min_u32 v23, 55, v1
  v_lshrrev_b32 v27, 3, v23
  v_add_u32 v27, s9, v27
  v_lshrrev_b32 v29, 2, v27
  v_lshlrev_b32 v29, 12, v29
  v_and_b32 v27, 3, v27
  v_lshl_add_u32 v27, v27, 6, v29
  v_bfe_u32 v29, v23, 2, 1
  v_lshl_add_u32 v27, v29, 11, v27
  v_and_b32 v29, 3, v23
  v_lshl_add_u32 v27, v29, 4, v27
  v_lshlrev_b32 v104, 5, v23
  v_add_u32 v104, 135168, v104
  v_lshlrev_b32 v105, 5, v1
  v_add_u32 v105, 131072, v105
  v_mov_b32 v28, v21
  v_lshrrev_b32 v20, 4, v1
  v_bfe_u32 v21, v1, 2, 2
  v_and_b32 v22, 3, v1
  v_cmp_eq_u32 s[46:47], v20, v21
  v_cmp_eq_u32 s[40:41], 1, v22
  v_cmp_eq_u32 s[42:43], 2, v22
  v_cmp_eq_u32 s[44:45], 3, v22
  v_lshl_add_u32 v24, v20, 3, v21
  v_lshlrev_b32 v24, 5, v24
  v_lshl_add_u32 v24, v22, 3, v24
  v_add_u32 v24, 137216, v24
  v_mov_b32 v112, 0x3f803f80
  v_mov_b32 v113, 0x3f803f80
  v_mov_b32 v114, 0x3f803f80
  v_mov_b32 v115, 0x3f803f80
  s_lshl_b32 s12, s8, 11
  s_add_u32 s12, s12, 0x40000
  s_add_u32 s28, s4, s12
  s_addc_u32 s29, s5, 0
  s_lshl_b32 s13, s13, 10
  s_lshr_b32 s12, s30, 1
  s_lshl_b32 s12, s12, 7
  s_add_u32 s12, s12, s13
  v_and_b32 v25, 15, v1
  v_lshl_add_u32 v25, v25, 3, s12
  v_lshlrev_b32 v26, 3, v1
  s_waitcnt vmcnt(32) lgkmcnt(0)
  s_barrier
  s_add_u32 s35, s48, 3
  s_and_b32 s35, s35, 7
  s_lshl_b32 s35, s35, 14
  s_mov_b32 m0, 49152
  s_nop 0
  buffer_load_dwordx4 v2, s[16:19], s35 offen offset:0 lds
  buffer_load_dwordx4 v2, s[16:19], s35 offen offset:1024 lds
  buffer_load_dwordx4 v2, s[16:19], s35 offen offset:2048 lds
  buffer_load_dwordx4 v2, s[16:19], s35 offen offset:3072 lds
  s_mov_b32 m0, 53248
  s_add_u32 s35, s35, 4096
  buffer_load_dwordx4 v2, s[16:19], s35 offen offset:0 lds
  buffer_load_dwordx4 v2, s[16:19], s35 offen offset:1024 lds
  buffer_load_dwordx4 v2, s[16:19], s35 offen offset:2048 lds
  buffer_load_dwordx4 v2, s[16:19], s35 offen offset:3072 lds
  s_mov_b32 m0, 57344
  s_add_u32 s35, s35, 4096
  buffer_load_dwordx4 v2, s[16:19], s35 offen offset:0 lds
  buffer_load_dwordx4 v2, s[16:19], s35 offen offset:1024 lds
  buffer_load_dwordx4 v2, s[16:19], s35 offen offset:2048 lds
  buffer_load_dwordx4 v2, s[16:19], s35 offen offset:3072 lds
  s_mov_b32 m0, 61440
  s_add_u32 s35, s35, 4096
  buffer_load_dwordx4 v2, s[16:19], s35 offen offset:0 lds
  buffer_load_dwordx4 v2, s[16:19], s35 offen offset:1024 lds
  buffer_load_dwordx4 v2, s[16:19], s35 offen offset:2048 lds
  buffer_load_dwordx4 v2, s[16:19], s35 offen offset:3072 lds
  s_mov_b32 m0, 137216
  s_nop 0
  buffer_load_dwordx4 v28, s[16:19], s31 offen lds
  s_add_u32 s31, s31, 8192
  s_mov_b32 m0, 138240
  s_nop 0
  buffer_load_dwordx4 v28, s[16:19], s31 offen lds
  s_add_u32 s31, s31, 8192
  s_mov_b32 m0, 139264
  s_nop 0
  buffer_load_dwordx4 v28, s[16:19], s31 offen lds
  s_add_u32 s31, s31, 8192
  s_mov_b32 m0, 140288
  s_nop 0
  buffer_load_dwordx4 v28, s[16:19], s31 offen lds
  s_add_u32 s31, s31, 8192
  s_mov_b32 m0, 141312
  s_nop 0
  buffer_load_dwordx4 v28, s[16:19], s31 offen lds
  s_add_u32 s31, s31, 8192
  s_mov_b32 m0, 142336
  s_nop 0
  buffer_load_dwordx4 v28, s[16:19], s31 offen lds
  s_add_u32 s31, s31, 8192
  s_mov_b32 m0, 143360
  s_nop 0
  buffer_load_dwordx4 v28, s[16:19], s31 offen lds
  s_add_u32 s31, s31, 8192
  s_mov_b32 m0, 144384
  s_nop 0
  buffer_load_dwordx4 v28, s[16:19], s31 offen lds
  s_add_u32 s31, s31, 8192
  s_waitcnt vmcnt(40)
  s_barrier
  s_add_u32 s35, s48, 4
  s_and_b32 s35, s35, 7
  s_lshl_b32 s35, s35, 14
  s_mov_b32 m0, 65536
  s_nop 0
  buffer_load_dwordx4 v2, s[16:19], s35 offen offset:0 lds
  buffer_load_dwordx4 v2, s[16:19], s35 offen offset:1024 lds
  buffer_load_dwordx4 v2, s[16:19], s35 offen offset:2048 lds
  buffer_load_dwordx4 v2, s[16:19], s35 offen offset:3072 lds
  s_mov_b32 m0, 69632
  s_add_u32 s35, s35, 4096
  buffer_load_dwordx4 v2, s[16:19], s35 offen offset:0 lds
  buffer_load_dwordx4 v2, s[16:19], s35 offen offset:1024 lds
  buffer_load_dwordx4 v2, s[16:19], s35 offen offset:2048 lds
  buffer_load_dwordx4 v2, s[16:19], s35 offen offset:3072 lds
  s_mov_b32 m0, 73728
  s_add_u32 s35, s35, 4096
  buffer_load_dwordx4 v2, s[16:19], s35 offen offset:0 lds
  buffer_load_dwordx4 v2, s[16:19], s35 offen offset:1024 lds
  buffer_load_dwordx4 v2, s[16:19], s35 offen offset:2048 lds
  buffer_load_dwordx4 v2, s[16:19], s35 offen offset:3072 lds
  s_mov_b32 m0, 77824
  s_add_u32 s35, s35, 4096
  buffer_load_dwordx4 v2, s[16:19], s35 offen offset:0 lds
  buffer_load_dwordx4 v2, s[16:19], s35 offen offset:1024 lds
  buffer_load_dwordx4 v2, s[16:19], s35 offen offset:2048 lds
  buffer_load_dwordx4 v2, s[16:19], s35 offen offset:3072 lds
  s_waitcnt vmcnt(16)
  ds_read_b64_tr_b16 v[32:33], v24 offset:0
  ds_read_b64_tr_b16 v[34:35], v24 offset:128
  ds_read_b64_tr_b16 v[36:37], v24 offset:1024
  ds_read_b64_tr_b16 v[38:39], v24 offset:1152
  ds_read_b64_tr_b16 v[40:41], v24 offset:2048
  ds_read_b64_tr_b16 v[42:43], v24 offset:2176
  ds_read_b64_tr_b16 v[44:45], v24 offset:3072
  ds_read_b64_tr_b16 v[46:47], v24 offset:3200
  ds_read_b64_tr_b16 v[48:49], v24 offset:4096
  ds_read_b64_tr_b16 v[50:51], v24 offset:4224
  ds_read_b64_tr_b16 v[52:53], v24 offset:5120
  ds_read_b64_tr_b16 v[54:55], v24 offset:5248
  ds_read_b64_tr_b16 v[56:57], v24 offset:6144
  ds_read_b64_tr_b16 v[58:59], v24 offset:6272
  ds_read_b64_tr_b16 v[60:61], v24 offset:7168
  ds_read_b64_tr_b16 v[62:63], v24 offset:7296
  s_waitcnt lgkmcnt(14)
  v_mfma_f32_16x16x32_bf16 v[120:123], v[32:35], v[32:35], 0
  v_mfma_f32_16x16x32_bf16 v[116:119], v[112:115], v[32:35], 0
  s_waitcnt lgkmcnt(12)
  v_mfma_f32_16x16x32_bf16 v[120:123], v[36:39], v[36:39], v[120:123]
  v_mfma_f32_16x16x32_bf16 v[116:119], v[112:115], v[36:39], v[116:119]
  s_waitcnt lgkmcnt(10)
  v_mfma_f32_16x16x32_bf16 v[120:123], v[40:43], v[40:43], v[120:123]
  v_mfma_f32_16x16x32_bf16 v[116:119], v[112:115], v[40:43], v[116:119]
  s_waitcnt lgkmcnt(8)
  v_mfma_f32_16x16x32_bf16 v[120:123], v[44:47], v[44:47], v[120:123]
  v_mfma_f32_16x16x32_bf16 v[116:119], v[112:115], v[44:47], v[116:119]
  s_waitcnt lgkmcnt(6)
  v_mfma_f32_16x16x32_bf16 v[120:123], v[48:51], v[48:51], v[120:123]
  v_mfma_f32_16x16x32_bf16 v[116:119], v[112:115], v[48:51], v[116:119]
  s_waitcnt lgkmcnt(4)
  v_mfma_f32_16x16x32_bf16 v[120:123], v[52:55], v[52:55], v[120:123]
  v_mfma_f32_16x16x32_bf16 v[116:119], v[112:115], v[52:55], v[116:119]
  s_waitcnt lgkmcnt(2)
  v_mfma_f32_16x16x32_bf16 v[120:123], v[56:59], v[56:59], v[120:123]
  v_mfma_f32_16x16x32_bf16 v[116:119], v[112:115], v[56:59], v[116:119]
  s_waitcnt lgkmcnt(0)
  v_mfma_f32_16x16x32_bf16 v[120:123], v[60:63], v[60:63], v[120:123]
  v_mfma_f32_16x16x32_bf16 v[116:119], v[112:115], v[60:63], v[116:119]
  s_nop 7
  v_cndmask_b32 v117, v120, v121, s[40:41]
  v_cndmask_b32 v117, v117, v122, s[42:43]
  v_cndmask_b32 v117, v117, v123, s[44:45]
  v_and_b32 v117, 0x7fffffff, v117
  s_mov_b64 exec, s[46:47]
  global_store_dwordx2 v25, v[116:117], s[28:29] sc1
  s_mov_b64 exec, -1
  s_waitcnt vmcnt(41)
  s_barrier
  s_add_u32 s35, s48, 5
  s_and_b32 s35, s35, 7
  s_lshl_b32 s35, s35, 14
  s_mov_b32 m0, 81920
  s_nop 0
  buffer_load_dwordx4 v2, s[16:19], s35 offen offset:0 lds
  buffer_load_dwordx4 v2, s[16:19], s35 offen offset:1024 lds
  buffer_load_dwordx4 v2, s[16:19], s35 offen offset:2048 lds
  buffer_load_dwordx4 v2, s[16:19], s35 offen offset:3072 lds
  s_mov_b32 m0, 86016
  s_add_u32 s35, s35, 4096
  buffer_load_dwordx4 v2, s[16:19], s35 offen offset:0 lds
  buffer_load_dwordx4 v2, s[16:19], s35 offen offset:1024 lds
  buffer_load_dwordx4 v2, s[16:19], s35 offen offset:2048 lds
  buffer_load_dwordx4 v2, s[16:19], s35 offen offset:3072 lds
  s_mov_b32 m0, 90112
  s_add_u32 s35, s35, 4096
  buffer_load_dwordx4 v2, s[16:19], s35 offen offset:0 lds
  buffer_load_dwordx4 v2, s[16:19], s35 offen offset:1024 lds
  buffer_load_dwordx4 v2, s[16:19], s35 offen offset:2048 lds
  buffer_load_dwordx4 v2, s[16:19], s35 offen offset:3072 lds
  s_mov_b32 m0, 94208
  s_add_u32 s35, s35, 4096
  buffer_load_dwordx4 v2, s[16:19], s35 offen offset:0 lds
  buffer_load_dwordx4 v2, s[16:19], s35 offen offset:1024 lds
  buffer_load_dwordx4 v2, s[16:19], s35 offen offset:2048 lds
  buffer_load_dwordx4 v2, s[16:19], s35 offen offset:3072 lds
  s_add_u32 s35, s48, 6
  s_and_b32 s35, s35, 7
  s_lshl_b32 s35, s35, 14
  s_mov_b32 m0, 98304
  s_nop 0
  buffer_load_dwordx4 v2, s[16:19], s35 offen offset:0 lds
  buffer_load_dwordx4 v2, s[16:19], s35 offen offset:1024 lds
  buffer_load_dwordx4 v2, s[16:19], s35 offen offset:2048 lds
  buffer_load_dwordx4 v2, s[16:19], s35 offen offset:3072 lds
  s_mov_b32 m0, 102400
  s_add_u32 s35, s35, 4096
  buffer_load_dwordx4 v2, s[16:19], s35 offen offset:0 lds
  buffer_load_dwordx4 v2, s[16:19], s35 offen offset:1024 lds
  buffer_load_dwordx4 v2, s[16:19], s35 offen offset:2048 lds
  buffer_load_dwordx4 v2, s[16:19], s35 offen offset:3072 lds
  s_mov_b32 m0, 106496
  s_add_u32 s35, s35, 4096
  buffer_load_dwordx4 v2, s[16:19], s35 offen offset:0 lds
  buffer_load_dwordx4 v2, s[16:19], s35 offen offset:1024 lds
  buffer_load_dwordx4 v2, s[16:19], s35 offen offset:2048 lds
  buffer_load_dwordx4 v2, s[16:19], s35 offen offset:3072 lds
  s_mov_b32 m0, 110592
  s_add_u32 s35, s35, 4096
  buffer_load_dwordx4 v2, s[16:19], s35 offen offset:0 lds
  buffer_load_dwordx4 v2, s[16:19], s35 offen offset:1024 lds
  buffer_load_dwordx4 v2, s[16:19], s35 offen offset:2048 lds
  buffer_load_dwordx4 v2, s[16:19], s35 offen offset:3072 lds
  global_load_dwordx4 v[64:67], v27, s[14:15] offset:0
  global_load_dwordx4 v[80:83], v27, s[14:15] offset:256
  global_load_dwordx4 v[68:71], v27, s[14:15] offset:512
  global_load_dwordx4 v[84:87], v27, s[14:15] offset:768
  global_load_dwordx4 v[72:75], v27, s[14:15] offset:1024
  global_load_dwordx4 v[88:91], v27, s[14:15] offset:1280
  global_load_dwordx4 v[76:79], v27, s[14:15] offset:1536
  global_load_dwordx4 v[92:95], v27, s[14:15] offset:1792
  s_waitcnt vmcnt(62)
  s_barrier
  s_add_u32 s35, s48, 7
  s_and_b32 s35, s35, 7
  s_lshl_b32 s35, s35, 14
  s_mov_b32 m0, 114688
  s_nop 0
  buffer_load_dwordx4 v2, s[16:19], s35 offen offset:0 lds
  buffer_load_dwordx4 v2, s[16:19], s35 offen offset:1024 lds
  buffer_load_dwordx4 v2, s[16:19], s35 offen offset:2048 lds
  buffer_load_dwordx4 v2, s[16:19], s35 offen offset:3072 lds
  s_mov_b32 m0, 118784
  s_add_u32 s35, s35, 4096
  buffer_load_dwordx4 v2, s[16:19], s35 offen offset:0 lds
  buffer_load_dwordx4 v2, s[16:19], s35 offen offset:1024 lds
  buffer_load_dwordx4 v2, s[16:19], s35 offen offset:2048 lds
  buffer_load_dwordx4 v2, s[16:19], s35 offen offset:3072 lds
  s_mov_b32 m0, 122880
  s_add_u32 s35, s35, 4096
  buffer_load_dwordx4 v2, s[16:19], s35 offen offset:0 lds
  buffer_load_dwordx4 v2, s[16:19], s35 offen offset:1024 lds
  buffer_load_dwordx4 v2, s[16:19], s35 offen offset:2048 lds
  buffer_load_dwordx4 v2, s[16:19], s35 offen offset:3072 lds
  s_mov_b32 m0, 126976
  s_add_u32 s35, s35, 4096
  buffer_load_dwordx4 v2, s[16:19], s35 offen offset:0 lds
  buffer_load_dwordx4 v2, s[16:19], s35 offen offset:1024 lds
  buffer_load_dwordx4 v2, s[16:19], s35 offen offset:2048 lds
  buffer_load_dwordx4 v2, s[16:19], s35 offen offset:3072 lds
  s_waitcnt vmcnt(16)
  v_pk_add_f32 v[64:65], v[64:65], v[68:69] op_sel:[0,0] op_sel_hi:[1,1]
  v_pk_add_f32 v[72:73], v[72:73], v[76:77] op_sel:[0,0] op_sel_hi:[1,1]
  v_pk_add_f32 v[66:67], v[66:67], v[70:71] op_sel:[0,0] op_sel_hi:[1,1]
  v_pk_add_f32 v[74:75], v[74:75], v[78:79] op_sel:[0,0] op_sel_hi:[1,1]
  v_pk_add_f32 v[64:65], v[64:65], v[72:73] op_sel:[0,0] op_sel_hi:[1,1]
  v_pk_add_f32 v[66:67], v[66:67], v[74:75] op_sel:[0,0] op_sel_hi:[1,1]
  v_pk_add_f32 v[80:81], v[80:81], v[84:85] op_sel:[0,0] op_sel_hi:[1,1]
  v_pk_add_f32 v[88:89], v[88:89], v[92:93] op_sel:[0,0] op_sel_hi:[1,1]
  v_pk_add_f32 v[82:83], v[82:83], v[86:87] op_sel:[0,0] op_sel_hi:[1,1]
  v_pk_add_f32 v[90:91], v[90:91], v[94:95] op_sel:[0,0] op_sel_hi:[1,1]
  v_pk_add_f32 v[80:81], v[80:81], v[88:89] op_sel:[0,0] op_sel_hi:[1,1]
  v_pk_add_f32 v[82:83], v[82:83], v[90:91] op_sel:[0,0] op_sel_hi:[1,1]
  v_cvt_pk_bf16_f32 v96, v64, v64
  v_and_b32 v68, 0xffff0000, v96
  v_sub_f32 v64, v64, v68
  v_cvt_pk_bf16_f32 v96, v68, v64
  v_cvt_pk_bf16_f32 v97, v80, v80
  v_and_b32 v84, 0xffff0000, v97
  v_sub_f32 v80, v80, v84
  v_cvt_pk_bf16_f32 v97, v84, v80
  v_cvt_pk_bf16_f32 v98, v65, v65
  v_and_b32 v69, 0xffff0000, v98
  v_sub_f32 v65, v65, v69
  v_cvt_pk_bf16_f32 v98, v69, v65
  v_cvt_pk_bf16_f32 v99, v81, v81
  v_and_b32 v85, 0xffff0000, v99
  v_sub_f32 v81, v81, v85
  v_cvt_pk_bf16_f32 v99, v85, v81
  v_cvt_pk_bf16_f32 v100, v66, v66
  v_and_b32 v70, 0xffff0000, v100
  v_sub_f32 v66, v66, v70
  v_cvt_pk_bf16_f32 v100, v70, v66
  v_cvt_pk_bf16_f32 v101, v82, v82
  v_and_b32 v86, 0xffff0000, v101
  v_sub_f32 v82, v82, v86
  v_cvt_pk_bf16_f32 v101, v86, v82
  v_cvt_pk_bf16_f32 v102, v67, v67
  v_and_b32 v71, 0xffff0000, v102
  v_sub_f32 v67, v67, v71
  v_cvt_pk_bf16_f32 v102, v71, v67
  v_cvt_pk_bf16_f32 v103, v83, v83
  v_and_b32 v87, 0xffff0000, v103
  v_sub_f32 v83, v83, v87
  v_cvt_pk_bf16_f32 v103, v87, v83
  ds_write_b128 v104, v[96:99]
  ds_write_b128 v104, v[100:103] offset:16
  s_lshr_b32 s37, s30, 3
  s_lshl_b32 s37, s37, 2
  s_and_b32 s38, s30, 3
  s_add_u32 s37, s37, s38
  s_bfe_u32 s38, s30, 0x10002
  s_and_b32 s39, s33, 1
  s_bfe_u32 s42, s33, 0x10001
  s_lshr_b32 s43, s33, 2
  s_and_b32 s49, s30, 3
  s_mul_i32 s49, s49, 0
  s_mul_i32 s12, s37, 229376
  s_mul_i32 s13, s33, 14336
  s_add_u32 s12, s12, s13
  s_add_u32 s12, s12, 0x1000000
  s_add_u32 s24, s4, s12
  s_addc_u32 s25, s5, 0
  s_mov_b32 s26, 129024
  s_mov_b32 s27, 0x20000
  s_lshl_b32 s12, s43, 8
  v_xor_b32 v12, s12, v2
  s_mul_i32 s12, s39, 114688
  v_add_u32 v3, s12, v12
  s_sub_u32 s12, 114688, s12
  v_add_u32 v12, s12, v12
  s_waitcnt vmcnt(57)
  s_barrier
  s_mov_b32 s36, 131072
  s_mov_b32 s12, 0x3b000000
  s_mov_b32 s14, 0x3727c5ac
K2_POLLS:
  global_load_dwordx2 v[64:65], v26, s[28:29] offset:0 sc1
  global_load_dwordx2 v[66:67], v26, s[28:29] offset:512 sc1
  global_load_dwordx2 v[68:69], v26, s[28:29] offset:1024 sc1
  global_load_dwordx2 v[70:71], v26, s[28:29] offset:1536 sc1
  s_waitcnt vmcnt(0)
  v_or_b32 v72, v65, v67
  v_or3_b32 v72, v72, v69, v71
  v_cmp_gt_i32 vcc, 0, v72
  s_nop 1
  s_cmp_eq_u64 vcc, 0
  s_cbranch_scc1 K2_GOS
  s_sleep 2
  s_sub_u32 s36, s36, 1
  s_cmp_lg_u32 s36, 0
  s_cbranch_scc1 K2_POLLS
K2_GOS:
  v_add_f32 v82, v64, v68
  v_add_f32 v83, v66, v70
  v_add_f32 v80, v65, v69
  v_add_f32 v81, v67, v71
  v_pk_mul_f32 v[82:83], v[82:83], s[12:13] op_sel:[0,0] op_sel_hi:[1,0]
  v_pk_mul_f32 v[80:81], v[80:81], s[12:13] op_sel:[0,0] op_sel_hi:[1,0]
  v_pk_fma_f32 v[80:81], v[82:83], v[82:83], v[80:81] op_sel:[0,0,0] op_sel_hi:[1,1,1] neg_lo:[1,0,0] neg_hi:[1,0,0]
  v_cvt_pk_bf16_f32 v88, -v82, -v82
  v_cvt_pk_bf16_f32 v96, -v83, -v83
  v_max_f32 v80, 0, v80
  v_max_f32 v81, 0, v81
  v_cvt_pk_bf16_f32 v84, v80, v81
  v_lshlrev_b32 v80, 16, v84
  v_and_b32 v81, 0xffff0000, v84
  v_pk_add_f32 v[80:81], v[80:81], s[14:15] op_sel:[0,0] op_sel_hi:[1,0]
  v_cvt_pk_bf16_f32 v84, v80, v81
  v_lshlrev_b32 v80, 16, v84
  v_and_b32 v81, 0xffff0000, v84
  v_sqrt_f32 v80, v80
  v_sqrt_f32 v81, v81
  v_pk_mov_b32 v[90:91], 0, 0
  v_pk_mov_b32 v[98:99], 0, 0
  v_cvt_pk_bf16_f32 v89, v80, v80
  v_cvt_pk_bf16_f32 v97, v81, v81
  v_lshlrev_b32 v80, 16, v89
  v_lshlrev_b32 v81, 16, v97
  v_rcp_f32 v82, v80
  v_rcp_f32 v83, v81
  ds_write_b128 v105, v[88:91]
  ds_write_b128 v105, v[96:99] offset:2048
  v_mul_f32 v94, v80, v80
  v_mul_f32 v102, v81, v81
  v_mul_f32 v92, 0xc0135761, v82
  v_mul_f32 v100, 0xc0135761, v83
  v_pk_mul_f32 v[82:83], v[82:83], v[82:83] op_sel:[0,0] op_sel_hi:[1,1]
  v_mul_f32 v82, 0x3d372713, v82
  v_mul_f32 v83, 0x3d372713, v83
  v_mul_f32 v93, v82, v92
  v_mul_f32 v101, v83, v100
  ds_write_b128 v105, v[92:95] offset:16
  ds_write_b128 v105, v[100:103] offset:2064
  s_waitcnt lgkmcnt(0)
  s_barrier
  s_add_u32 s44, s49, 0
  s_sub_u32 s47, s44, 14336
  s_cselect_b32 s44, s44, s47
  buffer_load_dwordx4 v[128:131], v3, s[24:27], s44 offen
  buffer_load_dwordx4 v[132:135], v12, s[24:27], s44 offen
  s_add_u32 s44, s49, 1024
  s_sub_u32 s47, s44, 14336
  s_cselect_b32 s44, s44, s47
  buffer_load_dwordx4 v[136:139], v3, s[24:27], s44 offen
  buffer_load_dwordx4 v[140:143], v12, s[24:27], s44 offen
  s_add_u32 s44, s49, 2048
  s_sub_u32 s47, s44, 14336
  s_cselect_b32 s44, s44, s47
  buffer_load_dwordx4 v[144:147], v3, s[24:27], s44 offen
  buffer_load_dwordx4 v[148:151], v12, s[24:27], s44 offen
  s_add_u32 s44, s49, 3072
  s_sub_u32 s47, s44, 14336
  s_cselect_b32 s44, s44, s47
  buffer_load_dwordx4 v[152:155], v3, s[24:27], s44 offen
  buffer_load_dwordx4 v[156:159], v12, s[24:27], s44 offen
  s_add_u32 s44, s49, 4096
  s_sub_u32 s47, s44, 14336
  s_cselect_b32 s44, s44, s47
  buffer_load_dwordx4 v[160:163], v3, s[24:27], s44 offen
  buffer_load_dwordx4 v[164:167], v12, s[24:27], s44 offen
  s_add_u32 s44, s49, 5120
  s_sub_u32 s47, s44, 14336
  s_cselect_b32 s44, s44, s47
  buffer_load_dwordx4 v[168:171], v3, s[24:27], s44 offen
  buffer_load_dwordx4 v[172:175], v12, s[24:27], s44 offen
  s_add_u32 s44, s49, 6144
  s_sub_u32 s47, s44, 14336
  s_cselect_b32 s44, s44, s47
  buffer_load_dwordx4 v[176:179], v3, s[24:27], s44 offen
  buffer_load_dwordx4 v[180:183], v12, s[24:27], s44 offen
  s_add_u32 s44, s49, 7168
  s_sub_u32 s47, s44, 14336
  s_cselect_b32 s44, s44, s47
  buffer_load_dwordx4 v[184:187], v3, s[24:27], s44 offen
  buffer_load_dwordx4 v[188:191], v12, s[24:27], s44 offen
  s_add_u32 s44, s49, 8192
  s_sub_u32 s47, s44, 14336
  s_cselect_b32 s44, s44, s47
  buffer_load_dwordx4 v[192:195], v3, s[24:27], s44 offen
  buffer_load_dwordx4 v[196:199], v12, s[24:27], s44 offen
  s_add_u32 s44, s49, 9216
  s_sub_u32 s47, s44, 14336
  s_cselect_b32 s44, s44, s47
  buffer_load_dwordx4 v[200:203], v3, s[24:27], s44 offen
  buffer_load_dwordx4 v[204:207], v12, s[24:27], s44 offen
  s_add_u32 s44, s49, 10240
  s_sub_u32 s47, s44, 14336
  s_cselect_b32 s44, s44, s47
  buffer_load_dwordx4 v[208:211], v3, s[24:27], s44 offen
  buffer_load_dwordx4 v[212:215], v12, s[24:27], s44 offen
  s_add_u32 s44, s49, 11264
  s_sub_u32 s47, s44, 14336
  s_cselect_b32 s44, s44, s47
  buffer_load_dwordx4 v[216:219], v3, s[24:27], s44 offen
  buffer_load_dwordx4 v[220:223], v12, s[24:27], s44 offen
  s_add_u32 s44, s49, 12288
  s_sub_u32 s47, s44, 14336
  s_cselect_b32 s44, s44, s47
  buffer_load_dwordx4 v[224:227], v3, s[24:27], s44 offen
  buffer_load_dwordx4 v[228:231], v12, s[24:27], s44 offen
  s_add_u32 s44, s49, 13312
  s_sub_u32 s47, s44, 14336
  s_cselect_b32 s44, s44, s47
  buffer_load_dwordx4 v[232:235], v3, s[24:27], s44 offen
  buffer_load_dwordx4 v[236:239], v12, s[24:27], s44 offen
  s_setprio 0
  s_waitcnt vmcnt(0)
  s_branch K2_P2
K2_END:
  s_endpgm
CODE_END:
.section .rodata,"a"
.p2align 6
.amdhsa_kernel prep_kernel
  .amdhsa_next_free_vgpr 256
  .amdhsa_next_free_sgpr 60
  .amdhsa_accum_offset 256
  .amdhsa_group_segment_fixed_size 0
  .amdhsa_kernarg_size 144
  .amdhsa_user_sgpr_count 2
  .amdhsa_user_sgpr_kernarg_segment_ptr 1
  .amdhsa_system_sgpr_workgroup_id_x 1
.end_amdhsa_kernel
.p2align 6
.amdhsa_kernel gemm1_kernel
  .amdhsa_next_free_vgpr 256
  .amdhsa_next_free_sgpr 60
  .amdhsa_accum_offset 256
  .amdhsa_group_segment_fixed_size 0
  .amdhsa_kernarg_size 144
  .amdhsa_user_sgpr_count 2
  .amdhsa_user_sgpr_kernarg_segment_ptr 1
  .amdhsa_system_sgpr_workgroup_id_x 1
.end_amdhsa_kernel
.p2align 8
K0_TAB:
.long 48896,48896,48896,48896
.long 48860,48860,48860,48828
.long 48828,48828,48828,48828
.long 48792,48792,48792,48760
.long 48760,48760,48760,48760
.long 48724,48724,48724,48692
.long 48692,48692,48692,48692
.long 48656,48656,48656,48624
.long 48624,48624,48624,48624
.long 48588,48588,48588,48556
.long 48556,48556,48556,48556
.long 48520,48520,48520,48488
.long 48488,48488,48488,48488
.long 48452,48452,48452,48420
.long 48420,48420,48420,48420
.long 48384,48384,48384,48352
.long 48352,48352,48352,48352
.long 48316,48316,48316,48284
.long 48284,48284,48284,48284
.long 48248,48248,48248,48216
.long 48216,48216,48216,48216
.long 48180,48180,48180,48148
.long 48148,48148,48148,48148
.long 48112,48112,48112,48080
.long 48080,48080,48080,48080
.long 48044,48044,48044,48012
.long 48012,48012,48012,48012
.long 47976,47976,47976,47944
.long 47944,47944,47944,47944
.long 47908,47908,47908,47876
.long 47876,47876,47876,47876
.long 47840,47840,47840,47808
.long 47808,47808,47808,47808
.long 47772,47772,47772,47740
.long 47740,47740,47740,47740
.long 47704,47704,47704,47672
.long 47672,47672,47672,47672
.long 47636,47636,47636,47604
.long 47604,47604,47604,47604
.long 47568,47568,47568,47536
.long 47536,47536,47536,47536
.long 47500,47500,47500,47468
.long 47468,47468,47468,47468
.long 47432,47432,47432,47400
.long 47400,47400,47400,47400
.long 47364,47364,47364,47332
.long 47332,47332,47332,47332
.long 47296,47296,47296,47264
.long 47264,47264,47264,47264
.long 47228,47228,47228,47196
.long 47196,47196,47196,47196
.long 47160,47160,47160,47128
.long 47128,47128,47128,47128
.long 47092,47092,47092,47060
.long 47060,47060,47060,47060
.long 47024,47024,47024,46992
.long 46992,46992,46992,46992
.long 46956,46956,46956,46924
.long 46924,46924,46924,46924
.long 46888,46888,46888,46856
.long 46856,46856,46856,46856
.long 46820,46820,46820,46788
.long 46788,46788,46788,46788
.long 46752,46752,46752,46720
.long 46720,46720,46720,46720
.long 46684,46684,46684,46652
.long 46652,46652,46652,46652
.long 46616,46616,46616,46584
.long 46584,46584,46584,46584
.long 46548,46548,46548,46516
.long 46516,46516,46516,46516
.long 46480,46480,46480,46448
.long 46448,46448,46448,46448
.long 46412,46412,46412,46380
.long 46380,46380,46380,46380
.long 46344,46344,46344,46312
.long 46312,46312,46312,46312
.long 46276,46276,46276,46244
.long 46244,46244,46244,46244
.long 46208,46208,46208,46176
.long 46176,46176,46176,46176
.long 46140,46140,46140,46108
.long 46108,46108,46108,46108
.long 46072,46072,46072,46040
.long 46040,46040,46040,46040
.long 46004,46004,46004,45972
.long 45972,45972,45972,45972
.long 45936,45936,45936,45904
.long 45904,45904,45904,45904
.long 45868,45868,45868,45836
.long 45836,45836,45836,45836
.long 45800,45800,45800,45768
.long 45768,45768,45768,45768
.long 45732,45732,45732,45700
.long 45700,45700,45700,45700
.long 45664,45664,45664,45632
.long 45632,45632,45632,45632
.long 45596,45596,45596,45564
.long 45564,45564,45564,45564
.long 45528,45528,45528,45496
.long 45496,45496,45496,45496
.long 45460,45460,45460,45428
.long 45428,45428,45428,45428
.long 45392,45392,45392,45360
.long 45360,45360,45360,45360
.long 45324,45324,45324,45292
.long 45292,45292,45292,45292
.long 45256,45256,45256,45224
.long 45224,45224,45224,45224
.long 45188,45188,45188,45156
.long 45156,45156,45156,45156
.long 45120,45120,45120,45088
.long 45088,45088,45088,45088
.long 45052,45052,45052,45020
.long 45020,45020,45020,45020
.long 44984,44984,44984,44952
.long 44952,44952,44952,44952
.long 44916,44916,44916,44884
.long 44884,44884,44884,44884
.long 44848,44848,44848,44816
.long 44816,44816,44816,44816
.long 44780,44780,44780,44748
.long 44748,44748,44748,44748
.long 44712,44712,44712,44680
.long 44680,44680,44680,44680
.long 44644,44644,44644,44612
.long 44612,44612,44612,44612
.long 44576,44576,44576,44544
.long 48860,48860,48860,48860
.long 48828,48828,48828,48828
.long 48792,48792,48792,48792
.long 48760,48760,48760,48760
.long 48724,48724,48724,48724
.long 48692,48692,48692,48692
.long 48656,48656,48656,48656
.long 48624,48624,48624,48624
.long 48588,48588,48588,48588
.long 48556,48556,48556,48556
.long 48520,48520,48520,48520
.long 48488,48488,48488,48488
.long 48452,48452,48452,48452
.long 48420,48420,48420,48420
.long 48384,48384,48384,48384
.long 48352,48352,48352,48352
.long 48316,48316,48316,48316
.long 48284,48284,48284,48284
.long 48248,48248,48248,48248
.long 48216,48216,48216,48216
.long 48180,48180,48180,48180
.long 48148,48148,48148,48148
.long 48112,48112,48112,48112
.long 48080,48080,48080,48080
.long 48044,48044,48044,48044
.long 48012,48012,48012,48012
.long 47976,47976,47976,47976
.long 47944,47944,47944,47944
.long 47908,47908,47908,47908
.long 47876,47876,47876,47876
.long 47840,47840,47840,47840
.long 47808,47808,47808,47808
.long 47772,47772,47772,47772
.long 47740,47740,47740,47740
.long 47704,47704,47704,47704
.long 47672,47672,47672,47672
.long 47636,47636,47636,47636
.long 47604,47604,47604,47604
.long 47568,47568,47568,47568
.long 47536,47536,47536,47536
.long 47500,47500,47500,47500
.long 47468,47468,47468,47468
.long 47432,47432,47432,47432
.long 47400,47400,47400,47400
.long 47364,47364,47364,47364
.long 47332,47332,47332,47332
.long 47296,47296,47296,47296
.long 47264,47264,47264,47264
.long 47228,47228,47228,47228
.long 47196,47196,47196,47196
.long 47160,47160,47160,47160
.long 47128,47128,47128,47128
.long 47092,47092,47092,47092
.long 47060,47060,47060,47060
.long 47024,47024,47024,47024
.long 46992,46992,46992,46992
.long 46956,46956,46956,46956
.long 46924,46924,46924,46924
.long 46888,46888,46888,46888
.long 46856,46856,46856,46856
.long 46820,46820,46820,46820
.long 46788,46788,46788,46788
.long 46752,46752,46752,46752
.long 46720,46720,46720,46720
.long 46684,46684,46684,46684
.long 46652,46652,46652,46652
.long 46616,46616,46616,46616
.long 46584,46584,46584,46584
.long 46548,46548,46548,46548
.long 46516,46516,46516,46516
.long 46480,46480,46480,46480
.long 46448,46448,46448,46448
.long 46412,46412,46412,46412
.long 46380,46380,46380,46380
.long 46344,46344,46344,46344
.long 46312,46312,46312,46312
.long 46276,46276,46276,46276
.long 46244,46244,46244,46244
.long 46208,46208,46208,46208
.long 46176,46176,46176,46176
.long 46140,46140,46140,46140
.long 46108,46108,46108,46108
.long 46072,46072,46072,46072
.long 46040,46040,46040,46040
.long 46004,46004,46004,46004
.long 45972,45972,45972,45972
.long 45936,45936,45936,45936
.long 45904,45904,45904,45904
.long 45868,45868,45868,45868
.long 45836,45836,45836,45836
.long 45800,45800,45800,45800
.long 45768,45768,45768,45768
.long 45732,45732,45732,45732
.long 45700,45700,45700,45700
.long 45664,45664,45664,45664
.long 45632,45632,45632,45632
.long 45596,45596,45596,45596
.long 45564,45564,45564,45564
.long 45528,45528,45528,45528
.long 45496,45496,45496,45496
.long 45460,45460,45460,45460
.long 45428,45428,45428,45428
.long 45392,45392,45392,45392
.long 45360,45360,45360,45360
.long 45324,45324,45324,45324
.long 45292,45292,45292,45292
.long 45256,45256,45256,45256
.long 45224,45224,45224,45224
.long 45188,45188,45188,45188
.long 45156,45156,45156,45156
.long 45120,45120,45120,45120
.long 45088,45088,45088,45088
.long 45052,45052,45052,45052
.long 45020,45020,45020,45020
.long 44984,44984,44984,44984
.long 44952,44952,44952,44952
.long 44916,44916,44916,44916
.long 44884,44884,44884,44884
.long 44848,44848,44848,44848
.long 44816,44816,44816,44816
.long 44780,44780,44780,44780
.long 44748,44748,44748,44748
.long 44712,44712,44712,44712
.long 44680,44680,44680,44680
.long 44644,44644,44644,44644
.long 44612,44612,44612,44612
.long 44576,44576,44576,44576
.long 44544,44544,44544,44544
.long 44544,44544,44524,44524
.long 44508,44508,44492,44492
.long 44476,44476,44456,44456
.long 44440,44440,44424,44424
.long 44408,44408,44388,44388
.long 44372,44372,44356,44356
.long 44340,44340,44320,44320
.long 44304,44304,44288,44288
.long 44272,44272,44252,44252
.long 44236,44236,44220,44220
.long 44204,44204,44184,44184
.long 44168,44168,44152,44152
.long 44136,44136,44116,44116
.long 44100,44100,44084,44084
.long 44068,44068,44048,44048
.long 44032,44032,44016,44016
.long 44000,44000,43980,43980
.long 43964,43964,43948,43948
.long 43932,43932,43912,43912
.long 43896,43896,43880,43880
.long 43864,43864,43844,43844
.long 43828,43828,43812,43812
.long 43796,43796,43776,43776
.long 43760,43760,43744,43744
.long 43728,43728,43708,43708
.long 43692,43692,43676,43676
.long 43660,43660,43640,43640
.long 43624,43624,43608,43608
.long 43592,43592,43572,43572
.long 43556,43556,43540,43540
.long 43524,43524,43504,43504
.long 43488,43488,43472,43472
.long 43456,43456,43436,43436
.long 43420,43420,43404,43404
.long 43388,43388,43368,43368
.long 43352,43352,43336,43336
.long 43320,43320,43300,43300
.long 43284,43284,43268,43268
.long 43252,43252,43232,43232
.long 43216,43216,43200,43200
.long 43184,43184,43164,43164
.long 43148,43148,43132,43132
.long 43116,43116,43096,43096
.long 43080,43080,43064,43064
.long 43048,43048,43028,43028
.long 43012,43012,42996,42996
.long 42980,42980,42960,42960
.long 42944,42944,42928,42928
.long 42912,42912,42892,42892
.long 42876,42876,42860,42860
.long 42844,42844,42824,42824
.long 42808,42808,42792,42792
.long 42776,42776,42756,42756
.long 42740,42740,42724,42724
.long 42708,42708,42688,42688
.long 42672,42672,42656,42656
.long 42640,42640,42620,42620
.long 42604,42604,42588,42588
.long 42572,42572,42552,42552
.long 42536,42536,42520,42520
.long 42504,42504,42484,42484
.long 42468,42468,42452,42452
.long 42436,42436,42416,42416
.long 42400,42400,42384,42384
.long 42368,42356,42348,42348
.long 42332,42324,42316,42316
.long 42300,42288,42280,42280
.long 42264,42256,42248,42248
.long 42232,42220,42212,42212
.long 42196,42188,42180,42180
.long 42164,42152,42144,42144
.long 42128,42120,42112,42112
.long 42096,42084,42076,42076
.long 42060,42052,42044,42044
.long 42028,42016,42008,42008
.long 41992,41984,41976,41976
.long 41960,41948,41940,41940
.long 41924,41916,41908,41908
.long 41892,41880,41872,41872
.long 41856,41848,41840,41840
.long 41824,41812,41804,41804
.long 41788,41780,41772,41772
.long 41756,41744,41736,41736
.long 41720,41712,41704,41704
.long 41688,41676,41668,41668
.long 41652,41644,41636,41636
.long 41620,41608,41600,41600
.long 41584,41576,41568,41568
.long 41552,41540,41532,41532
.long 41516,41508,41500,41500
.long 41484,41472,41464,41464
.long 41448,41440,41432,41432
.long 41416,41404,41396,41396
.long 41380,41372,41364,41364
.long 41348,41336,41328,41328
.long 41312,41304,41296,41296
.long 41272,41268,41264,41260
.long 41240,41236,41232,41228
.long 41204,41200,41196,41192
.long 41172,41168,41164,41160
.long 41136,41132,41128,41124
.long 41104,41100,41096,41092
.long 41068,41064,41060,41056
.long 41036,41032,41028,41024
.long 41000,40996,40992,40988
.long 40968,40964,40960,40956
.long 40932,40928,40924,40920
.long 40900,40896,40892,40888
.long 40864,40860,40856,40852
.long 40832,40828,40824,40820
.long 40796,40792,40788,40784
.long 40764,40760,40756,40752
.long 40728,40724,40720,40716
.long 40696,40692,40688,40684
.long 40660,40656,40652,40648
.long 40628,40624,40620,40616
.long 40592,40588,40584,40580
.long 40560,40556,40552,40548
.long 40524,40520,40516,40512
.long 40492,40488,40484,40480
.long 40456,40452,40448,40444
.long 40424,40420,40416,40412
.long 40388,40384,40380,40376
.long 40356,40352,40348,40344
.long 40320,40316,40312,40308
.long 40288,40284,40280,40276
.long 40252,40248,40244,40240
.long 40220,40216,40212,40208
.long 44524,44508,44508,44508
.long 44492,44476,44476,44476
.long 44456,44440,44440,44440
.long 44424,44408,44408,44408
.long 44388,44372,44372,44372
.long 44356,44340,44340,44340
.long 44320,44304,44304,44304
.long 44288,44272,44272,44272
.long 44252,44236,44236,44236
.long 44220,44204,44204,44204
.long 44184,44168,44168,44168
.long 44152,44136,44136,44136
.long 44116,44100,44100,44100
.long 44084,44068,44068,44068
.long 44048,44032,44032,44032
.long 44016,44000,44000,44000
.long 43980,43964,43964,43964
.long 43948,43932,43932,43932
.long 43912,43896,43896,43896
.long 43880,43864,43864,43864
.long 43844,43828,43828,43828
.long 43812,43796,43796,43796
.long 43776,43760,43760,43760
.long 43744,43728,43728,43728
.long 43708,43692,43692,43692
.long 43676,43660,43660,43660
.long 43640,43624,43624,43624
.long 43608,43592,43592,43592
.long 43572,43556,43556,43556
.long 43540,43524,43524,43524
.long 43504,43488,43488,43488
.long 43472,43456,43456,43456
.long 43436,43420,43420,43420
.long 43404,43388,43388,43388
.long 43368,43352,43352,43352
.long 43336,43320,43320,43320
.long 43300,43284,43284,43284
.long 43268,43252,43252,43252
.long 43232,43216,43216,43216
.long 43200,43184,43184,43184
.long 43164,43148,43148,43148
.long 43132,43116,43116,43116
.long 43096,43080,43080,43080
.long 43064,43048,43048,43048
.long 43028,43012,43012,43012
.long 42996,42980,42980,42980
.long 42960,42944,42944,42944
.long 42928,42912,42912,42912
.long 42892,42876,42876,42876
.long 42860,42844,42844,42844
.long 42824,42808,42808,42808
.long 42792,42776,42776,42776
.long 42756,42740,42740,42740
.long 42724,42708,42708,42708
.long 42688,42672,42672,42672
.long 42656,42640,42640,42640
.long 42620,42604,42604,42604
.long 42588,42572,42572,42572
.long 42552,42536,42536,42536
.long 42520,42504,42504,42504
.long 42484,42468,42468,42468
.long 42452,42436,42436,42436
.long 42416,42400,42400,42400
.long 42384,42368,42368,42368
.long 42348,42340,42332,42332
.long 42316,42308,42300,42300
.long 42280,42272,42264,42264
.long 42248,42240,42232,42232
.long 42212,42204,42196,42196
.long 42180,42172,42164,42164
.long 42144,42136,42128,42128
.long 42112,42104,42096,42096
.long 42076,42068,42060,42060
.long 42044,42036,42028,42028
.long 42008,42000,41992,41992
.long 41976,41968,41960,41960
.long 41940,41932,41924,41924
.long 41908,41900,41892,41892
.long 41872,41864,41856,41856
.long 41840,41832,41824,41824
.long 41804,41796,41788,41788
.long 41772,41764,41756,41756
.long 41736,41728,41720,41720
.long 41704,41696,41688,41688
.long 41668,41660,41652,41652
.long 41636,41628,41620,41620
.long 41600,41592,41584,41584
.long 41568,41560,41552,41552
.long 41532,41524,41516,41516
.long 41500,41492,41484,41484
.long 41464,41456,41448,41448
.long 41432,41424,41416,41416
.long 41396,41388,41380,41380
.long 41364,41356,41348,41348
.long 41328,41320,41312,41312
.long 41296,41288,41280,41280
.long 41256,41252,41248,41244
.long 41224,41220,41216,41212
.long 41188,41184,41180,41176
.long 41156,41152,41148,41144
.long 41120,41116,41112,41108
.long 41088,41084,41080,41076
.long 41052,41048,41044,41040
.long 41020,41016,41012,41008
.long 40984,40980,40976,40972
.long 40952,40948,40944,40940
.long 40916,40912,40908,40904
.long 40884,40880,40876,40872
.long 40848,40844,40840,40836
.long 40816,40812,40808,40804
.long 40780,40776,40772,40768
.long 40748,40744,40740,40736
.long 40712,40708,40704,40700
.long 40680,40676,40672,40668
.long 40644,40640,40636,40632
.long 40612,40608,40604,40600
.long 40576,40572,40568,40564
.long 40544,40540,40536,40532
.long 40508,40504,40500,40496
.long 40476,40472,40468,40464
.long 40440,40436,40432,40428
.long 40408,40404,40400,40396
.long 40372,40368,40364,40360
.long 40340,40336,40332,40328
.long 40304,40300,40296,40292
.long 40272,40268,40264,40260
.long 40236,40232,40228,40224
.long 40204,40200,40196,40192
```
